```python
import torch

def _softmax(x, axis=-1):
    return torch.softmax(x, dim=axis)
def _gelu(x):
    return torch.nn.functional.gelu(x, approximate="tanh")
def _silu(x):
    return torch.nn.functional.silu(x)
def _sigmoid(x):
    return torch.sigmoid(x)
def _layernorm(x, axis=-1, eps=1e-5):
    m = x.mean(dim=axis, keepdim=True)
    v = x.var(dim=axis, keepdim=True, unbiased=False)
    return (x - m) / torch.sqrt(v + eps)
def _scatter_add(tgt, idx, src, axis=0):
    return tgt.clone().index_add_(axis, idx, src)
def _segment_sum(src, seg, n):
    out = torch.zeros((n,) + src.shape[1:], dtype=src.dtype)
    return out.index_add_(0, seg, src)
def _pad(x, pw):
    flat = tuple(v for pair in reversed(pw) for v in pair)
    return torch.nn.functional.pad(x, flat)

kernel_name = 'gated_mix__sliding_block__dense_activation_relu__prompt'

def setup_inputs():

    _w = (lambda a: (lambda t: t.to(torch.bfloat16) if t.is_floating_point() else t)(torch.as_tensor(a)))
    def _A_setup():
        B, S, D = 1, 2048, 448
        return {
            "x": _w((lambda *s: torch.randn(*s, dtype=torch.bfloat16) * 0.05)(B, S, D)),
            "wqkv": _w((lambda *s: torch.randn(*s, dtype=torch.bfloat16) * 1.6)(D, 3 * D)),
            "wo": _w((lambda *s: torch.randn(*s, dtype=torch.bfloat16) * 0.05)(D, D)),
        }
    _A_in = _A_setup()

    def _B_setup():
        B, S, D, Dff = 1, 2048, 448, 1792
        return {
            "x": _w((lambda *s: torch.randn(*s, dtype=torch.bfloat16) * 0.05)(B, S, D)),
            "w1": _w((lambda *s: torch.randn(*s, dtype=torch.bfloat16) * 0.2)(D, Dff)),
            "w2": _w((lambda *s: torch.randn(*s, dtype=torch.bfloat16) * 0.2)(Dff, D)),
        }
    _B_in = _B_setup()

    return {
        "A_x": _A_in["x"],
        "A_wqkv": _A_in["wqkv"],
        "A_wo": _A_in["wo"],
        "B_x": _B_in["x"],
        "B_w1": _B_in["w1"],
        "B_w2": _B_in["w2"],
        "gate_w": _w((lambda *s: torch.randn(*s, dtype=torch.bfloat16) * 0.05)(448) * 16.0),
    }

def reference(A_x, A_wqkv, A_wo, B_x, B_w1, B_w2, gate_w):
    def _A_ref(x, wqkv, wo):
        B, S, D = x.shape
        H = 16; Dh = D // H; W = 256
        qkv = (lambda x, *d: x.permute(*d))((x @ wqkv).reshape(B, S, 3, H, Dh), 2, 0, 3, 1, 4)
        q, k, v = qkv[0], qkv[1], qkv[2]
        scores = torch.einsum("bhqd,bhkd->bhqk", q, k) * (Dh ** -0.5)
        idx = torch.arange(S)
        mask = (idx[:, None] - idx[None, :] >= 0) & (idx[:, None] - idx[None, :] < W)
        scores = torch.where(mask[None, None], scores, -1e9)
        p = _softmax(scores, axis=-1)
        o = torch.einsum("bhqk,bhkd->bhqd", p, v)
        return (lambda x, *d: x.permute(*d))(o, 0, 2, 1, 3).reshape(B, S, D) @ wo

    def _B_ref(x, w1, w2):
        h = torch.einsum("bsd,df->bsf", x, w1)
        zero = torch.zeros_like(h)
        h = torch.maximum(h, zero)
        return torch.einsum("bsf,fd->bsd", h, w2)

    x = A_x
    g = _sigmoid((x * gate_w).sum(-1, keepdims=True))
    a = _A_ref(x, A_wqkv, A_wo)
    b = _B_ref(x, B_w1, B_w2)
    return g * a + (1 - g) * b
```

```asm
; @launch grid=(256,1,1) block=(256,1,1) lds=163840
.amdgcn_target "amdgcn-amd-amdhsa--gfx950"
.text
.globl gated_mix__sliding_block__dense_activation_relu__prompt_kernel
.p2align 8
.type gated_mix__sliding_block__dense_activation_relu__prompt_kernel,@function
gated_mix__sliding_block__dense_activation_relu__prompt_kernel:
    s_cmp_ge_u32 s2, 256
    s_cbranch_scc1 L_end
    s_load_dwordx16 s[36:51], s[0:1], 0
    s_load_dwordx4 s[52:55], s[0:1], 64
    s_getpc_b64 s[86:87]
    s_lshr_b32 s62, s2, 3
    v_lshrrev_b32 v2, 6, v0
    v_and_b32 v3, 3, v0
    v_readfirstlane_b32 s3, v2
    v_lshl_add_u32 v3, v2, 2, v3
    s_lshl_b32 s63, s62, 11
    v_lshl_add_u32 v3, v3, 7, s63
    global_load_dword v9, v3, s[86:87]
    v_and_b32 v6, 63, v0
    s_and_b32 s61, s2, 7
    s_and_b32 s63, s62, 3
    s_lshr_b32 s59, s62, 2
    s_lshl_b32 s58, s61, 2
    s_add_u32 s58, s58, s63
    s_and_b32 s56, s58, 15
    s_lshr_b32 s64, s61, 2
    s_lshl_b32 s57, s64, 3
    s_add_u32 s57, s57, s59
    s_lshl_b32 s79, s63, 1
    s_add_u32 s79, s79, s59
    s_sub_u32 s61, s79, 7
    s_cmp_ge_u32 s79, 7
    s_cselect_b32 s79, s61, s79
    s_mov_b32 s66, s79
    s_mov_b32 s67, s79
    s_lshl_b32 s60, s56, 2
    s_add_u32 s60, s60, s3
    v_lshrrev_b32 v19, 3, v6
    v_mul_u32_u24 v4, 896, v19
    v_lshrrev_b32 v2, 4, v6
    v_and_b32 v5, 7, v6
    v_xor_b32 v5, v5, v2
    v_lshl_add_u32 v10, v5, 4, v4
    v_add_u32 v12, 12288, v10
    v_xor_b32 v5, 4, v5
    v_lshl_add_u32 v11, v5, 4, v4
    v_add_u32 v13, 18432, v11
    v_add_u32 v11, 6144, v11
    v_and_b32 v2, 1, v2
    v_lshlrev_b32 v2, 2, v2
    v_and_b32 v5, 7, v6
    v_xor_b32 v5, v5, v2
    v_lshlrev_b32 v18, 4, v5
    v_mul_u32_u24 v4, 2688, v19
    v_add_u32 v14, v4, v18
    v_add_u32 v15, 20480, v14
    s_mul_i32 s68, s60, 28672
    s_lshl_b32 s73, s3, 11
    s_lshl_b32 s72, s3, 12
    s_add_u32 s72, s72, 65536
    s_mul_i32 s69, s3, 43008
    s_lshl_b32 s61, s57, 7
    s_add_u32 s69, s69, s61
    s_waitcnt lgkmcnt(0)
    s_mov_b32 s4, s36
    s_and_b32 s5, s37, 0xffff
    s_mov_b32 s6, 1835008
    s_mov_b32 s7, 0x00020000
    s_add_u32 m0, s72, 0
    s_lshl_b32 s74, s66, 7
    s_add_u32 s74, s74, s68
    buffer_load_dwordx4 v10, s[4:7], s74 offen offset:0 lds
    buffer_load_dwordx4 v11, s[4:7], s74 offen offset:1024 lds
    buffer_load_dwordx4 v12, s[4:7], s74 offen offset:2048 lds
    buffer_load_dwordx4 v13, s[4:7], s74 offen offset:3072 lds
    s_add_u32 s66, s66, 1
    s_cmp_eq_u32 s66, 7
    s_cselect_b32 s66, 0, s66
    s_mov_b32 s8, s38
    s_and_b32 s9, s39, 0xffff
    s_mov_b32 s10, 1204224
    s_mov_b32 s11, 0x00020000
    s_add_u32 m0, s73, 0
    s_mul_i32 s75, s67, 172032
    s_add_u32 s75, s75, s69
    buffer_load_dwordx4 v14, s[8:11], s75 offen lds
    buffer_load_dwordx4 v15, s[8:11], s75 offen offset:1024 lds
    s_add_u32 s67, s67, 1
    s_cmp_eq_u32 s67, 7
    s_cselect_b32 s67, 0, s67
    s_mov_b32 s28, s54
    s_and_b32 s29, s55, 0xffff
    s_mov_b32 s30, 16777216
    s_mov_b32 s31, 0x00020000
    s_mov_b32 s12, s44
    s_and_b32 s13, s45, 0xffff
    s_mov_b32 s14, 1605632
    s_mov_b32 s15, 0x00020000
    s_mov_b32 s24, s40
    s_and_b32 s25, s41, 0xffff
    s_mov_b32 s26, 401408
    s_mov_b32 s27, 0x00020000
    s_mov_b32 s20, s46
    s_and_b32 s21, s47, 0xffff
    s_mov_b32 s22, 1605632
    s_mov_b32 s23, 0x00020000
    s_mov_b32 s32, s50
    s_and_b32 s33, s51, 0xffff
    s_mov_b32 s34, 1835008
    s_mov_b32 s35, 0x00020000
    s_mov_b64 s[88:89], s[48:49]
    v_mov_b32 v2, 0
    buffer_load_dword v20, v2, s[28:31], 0 offen sc1
    s_mov_b32 s84, s57
    s_lshl_b32 s83, s56, 2
    s_add_u32 s83, s83, s3
    v_lshrrev_b32 v7, 5, v6
    v_and_b32 v8, 31, v6
    v_bfe_u32 v2, v6, 1, 3
    v_xor_b32 v2, v2, v7
    v_lshlrev_b32 v4, 7, v8
    v_add_u32 v4, s72, v4
    v_xor_b32 v5, 0, v2
    v_lshl_add_u32 v21, v5, 4, v4
    v_xor_b32 v5, 2, v2
    v_lshl_add_u32 v22, v5, 4, v4
    v_xor_b32 v5, 4, v2
    v_lshl_add_u32 v23, v5, 4, v4
    v_xor_b32 v5, 6, v2
    v_lshl_add_u32 v24, v5, 4, v4
    v_bfe_u32 v30, v6, 2, 2
    v_bfe_u32 v2, v6, 4, 1
    v_lshlrev_b32 v31, 5, v2
    v_and_b32 v2, 3, v6
    v_lshl_add_u32 v31, v2, 3, v31
    v_lshrrev_b32 v2, 1, v30
    v_lshl_add_u32 v3, v2, 6, v31
    v_lshl_add_u32 v3, v30, 7, v3
    v_lshl_add_u32 v25, v7, 10, v3
    v_xor_b32 v26, 64, v25
    s_and_b32 s61, s57, 8
    s_lshl_b32 s61, s61, 3
    v_xor_b32 v27, s61, v25
    s_add_u32 m0, s72, 16384
    s_lshl_b32 s74, s66, 7
    s_add_u32 s74, s74, s68
    buffer_load_dwordx4 v10, s[4:7], s74 offen offset:0 lds
    buffer_load_dwordx4 v11, s[4:7], s74 offen offset:1024 lds
    s_lshl_b32 s44, s3, 12
    s_mul_i32 s45, s3, 12288
    s_add_u32 s45, s45, 114688
    v_lshl_add_u32 v3, v7, 9, v3
    s_lshr_b32 s61, s3, 1
    s_lshl_b32 s61, s61, 6
    v_xor_b32 v3, s61, v3
    v_add_u32 v33, s44, v3
    v_add_u32 v35, s45, v3
    v_xor_b32 v34, 64, v33
    v_xor_b32 v36, 64, v35
    v_mul_u32_u24 v4, 3584, v19
    v_add_u32 v16, v4, v18
    v_add_u32 v17, 27648, v16
    v_mul_u32_u24 v4, 896, v19
    v_add_u32 v37, v4, v18
    v_add_u32 v38, 6144, v37
    v_add_u32 v39, 12288, v37
    v_add_u32 v40, 18432, v37
    v_mov_b32 v42, 2130706432
    v_cmp_eq_u32 vcc, 0, v7
    v_lshlrev_b32 v32, 4, v6
    s_nop 0
    v_cndmask_b32 v41, v42, v40, vcc
    v_mov_b32 v2, 0xf149
    v_cndmask_b32 v43, v2, 0, vcc
    buffer_load_dwordx4 v12, s[4:7], s74 offen offset:2048 lds
    buffer_load_dwordx4 v13, s[4:7], s74 offen offset:3072 lds
    s_add_u32 s66, s66, 1
    s_cmp_eq_u32 s66, 7
    s_cselect_b32 s66, 0, s66
    s_add_u32 m0, s73, 8192
    s_mul_i32 s75, s67, 172032
    s_add_u32 s75, s75, s69
    buffer_load_dwordx4 v14, s[8:11], s75 offen lds
    s_lshr_b32 s64, s57, 3
    s_add_u32 s62, s57, 11
    s_sub_u32 s62, s62, s64
    s_add_u32 s63, s64, 25
    s_cmp_eq_u32 s59, 7
    s_cselect_b32 s62, s63, s62
    s_and_b32 s61, s62, 3
    s_mul_i32 s61, s61, 7
    s_lshr_b32 s78, s62, 2
    s_add_u32 s78, s78, s61
    s_mul_i32 s63, s64, 3
    s_sub_u32 s62, s57, s63
    s_sub_u32 s62, s62, 3
    s_add_u32 s71, s64, 9
    s_cmp_eq_u32 s59, 7
    s_cselect_b32 s62, s71, s62
    s_and_b32 s61, s62, 3
    s_mul_i32 s61, s61, 7
    s_lshr_b32 s77, s62, 2
    s_add_u32 s77, s77, s61
    s_add_u32 s63, s63, s59
    s_add_u32 s63, s63, 16
    s_add_u32 s76, s59, s64
    s_cmp_lt_u32 s76, 3
    s_cselect_b32 s77, s63, s77
    s_cselect_b32 s16, s8, s12
    s_cselect_b32 s17, s9, s13
    s_cselect_b32 s18, s10, s14
    s_mov_b32 s19, 0x00020000
    s_cselect_b64 vcc, -1, 0
    s_mov_b32 s63, 57344
    s_cselect_b32 s80, 43008, s63
    v_cndmask_b32 v18, v16, v14, vcc
    v_cndmask_b32 v19, v17, v15, vcc
    s_mul_i32 s70, s3, s80
    s_lshl_b32 s61, s77, 7
    s_add_u32 s70, s70, s61
    s_lshl_b32 s80, s80, 2
    v_mul_u32_u24 v28, 21504, v7
    v_lshl_add_u32 v28, v8, 4, v28
    s_add_u32 s61, s77, 32
    s_cmp_lt_u32 s76, 3
    s_cselect_b32 s61, s77, s61
    s_sub_u32 s61, s61, s57
    v_mul_u32_u24 v2, s61, v6
    s_lshl_b32 s62, s60, 6
    s_add_u32 s62, s62, s57
    v_add_u32 v2, s62, v2
    v_lshlrev_b32 v29, 6, v2
    s_add_u32 s61, s61, s62
    s_lshl_b32 s63, s60, 6
    s_add_u32 s63, s63, 21
    s_cmp_eq_u32 s59, 7
    s_cselect_b32 s61, s63, s61
    s_lshl_b32 s61, s61, 6
    v_writelane_b32 v29, s61, 2
    s_add_u32 s61, s63, s78
    s_add_u32 s61, s61, 11
    s_lshl_b32 s61, s61, 6
    v_writelane_b32 v29, s61, 3
    s_lshl_b32 s61, s83, 4
    s_add_u32 s61, s61, s84
    s_lshl_b32 s61, s61, 6
    s_add_u32 s61, s61, 524288
    v_writelane_b32 v29, s61, 4
    s_lshr_b32 s61, s57, 3
    s_add_u32 s61, s61, s63
    s_add_u32 s61, s61, 38
    s_lshl_b32 s61, s61, 6
    v_writelane_b32 v29, s61, 5
    buffer_load_dwordx4 v15, s[8:11], s75 offen offset:1024 lds
    s_add_u32 s67, s67, 1
    s_cmp_eq_u32 s67, 7
    s_cselect_b32 s67, 0, s67
    s_add_u32 m0, s72, 32768
    s_lshl_b32 s74, s66, 7
    s_add_u32 s74, s74, s68
    buffer_load_dwordx4 v10, s[4:7], s74 offen offset:0 lds
    buffer_load_dwordx4 v11, s[4:7], s74 offen offset:1024 lds
    v_mul_u32_u24 v4, 21504, v7
    v_lshlrev_b32 v2, 2, v7
    v_xor_b32 v2, v2, v8
    v_lshl_add_u32 v5, v2, 4, v4
    v_cmp_gt_u32 vcc, 28, v2
    s_nop 1
    v_cndmask_b32 v44, v42, v5, vcc
    v_lshlrev_b32 v2, 2, v7
    v_xor_b32 v2, v2, v8
    v_xor_b32 v2, 8, v2
    v_lshl_add_u32 v5, v2, 4, v4
    v_cmp_gt_u32 vcc, 28, v2
    v_add_u32 v5, 41984, v5
    s_nop 0
    v_cndmask_b32 v45, v42, v5, vcc
    v_mov_b32 v46, v28
    v_add_u32 v47, 41984, v28
    v_bfe_u32 v2, v6, 4, 1
    v_and_b32 v3, 1, v6
    v_lshl_add_u32 v4, v2, 1, v3
    v_lshlrev_b32 v5, 9, v4
    v_bfe_u32 v2, v6, 1, 1
    v_lshl_add_u32 v5, v2, 3, v5
    v_lshlrev_b32 v4, 2, v4
    v_lshl_add_u32 v2, v7, 3, v30
    v_xor_b32 v2, v2, v4
    v_lshl_add_u32 v5, v2, 4, v5
    s_add_u32 s61, s73, 65536
    s_add_u32 s62, s45, 8192
    v_add_u32 v48, s61, v5
    v_add_u32 v50, s62, v5
    v_xor_b32 v49, 64, v48
    v_xor_b32 v51, 64, v50
    v_add_u32 v52, s61, v32
    buffer_load_dwordx4 v12, s[4:7], s74 offen offset:2048 lds
    buffer_load_dwordx4 v13, s[4:7], s74 offen offset:3072 lds
    s_add_u32 s66, s66, 1
    s_cmp_eq_u32 s66, 7
    s_cselect_b32 s66, 0, s66
    s_add_u32 m0, s73, 16384
    s_mul_i32 s75, s67, 172032
    s_add_u32 s75, s75, s69
    buffer_load_dwordx4 v14, s[8:11], s75 offen lds
    s_and_b32 s61, s3, 1
    s_lshl_b32 s46, s58, 1
    s_add_u32 s46, s46, s61
    s_xor_b32 s62, s46, 1
    s_mul_i32 s63, s46, 114688
    s_cmp_eq_u32 s59, 7
    s_cselect_b32 s63, 2130706432, s63
    v_add_u32 v30, s63, v32
    s_lshl_b32 s63, s46, 15
    v_add_u32 v53, s63, v32
    s_mul_i32 s63, s62, 114688
    s_cmp_eq_u32 s59, 7
    s_cselect_b32 s63, 2130706432, s63
    v_add_u32 v31, s63, v32
    s_lshl_b32 s63, s62, 15
    v_add_u32 v54, s63, v32
    s_add_u32 s42, s58, s59
    s_and_b32 s42, s42, 3
    s_and_b32 s61, s58, 3
    s_lshl_b32 s61, s61, 1
    s_add_u32 s43, s61, s59
    s_and_b32 s43, s43, 7
    buffer_load_dwordx4 v15, s[8:11], s75 offen offset:1024 lds
    s_add_u32 s67, s67, 1
    s_cmp_eq_u32 s67, 7
    s_cselect_b32 s67, 0, s67
    s_add_u32 m0, s72, 49152
    s_lshl_b32 s74, s66, 7
    s_add_u32 s74, s74, s68
    buffer_load_dwordx4 v10, s[4:7], s74 offen offset:0 lds
    s_mul_i32 s37, s3, 401408
    s_lshl_b32 s61, s59, 7
    s_add_u32 s37, s37, s61
    s_add_u32 s38, s37, 114688
    s_mul_i32 s36, s42, 28672
    s_add_u32 s36, s36, s37
    s_mul_i32 s40, s3, 28672
    s_add_u32 s40, s40, 7340032
    s_add_u32 s41, s40, 8192
    s_lshl_b32 s39, s42, 11
    s_add_u32 s39, s39, s40
    buffer_load_dwordx4 v11, s[4:7], s74 offen offset:1024 lds
    buffer_load_dwordx4 v12, s[4:7], s74 offen offset:2048 lds
    v_lshrrev_b32 v2, 4, v6
    v_and_b32 v3, 15, v6
    s_mul_i32 s61, s3, 3
    s_lshl_b32 s62, s56, 2
    s_add_u32 s61, s61, s62
    s_sub_u32 s81, s61, 8
    v_add_u32 v4, s81, v2
    v_max_i32 v4, 0, v4
    v_lshlrev_b32 v4, 6, v4
    v_add_u32 v4, 7, v4
    s_lshl_b32 s62, s83, 6
    v_mov_b32 v5, s62
    v_cmp_eq_u32 vcc, 3, v2
    s_nop 1
    v_cndmask_b32 v4, v4, v5, vcc
    v_add_u32 v4, v4, v3
    v_lshlrev_b32 v55, 6, v4
    s_lshl_b32 s61, s58, 1
    v_add_u32 v4, s61, v2
    v_lshl_add_u32 v57, v4, 4, v3
    v_lshlrev_b32 v57, 6, v57
    v_lshlrev_b32 v4, 6, v4
    v_cmp_eq_u32 vcc, 0, v7
    s_mul_i32 s61, s3, 7
    s_add_u32 s61, s61, 32
    v_cndmask_b32 v4, v5, v4, vcc
    v_cndmask_b32 v57, v42, v57, vcc
    v_add_u32 v5, s61, v3
    v_cmp_gt_u32 vcc, 8, v3
    s_nop 1
    v_cndmask_b32 v5, 21, v5, vcc
    v_add_u32 v4, v4, v5
    v_lshlrev_b32 v56, 6, v4
    buffer_load_dwordx4 v13, s[4:7], s74 offen offset:3072 lds
    s_add_u32 s66, s66, 1
    s_cmp_eq_u32 s66, 7
    s_cselect_b32 s66, 0, s66
    s_add_u32 m0, s73, 24576
    s_mul_i32 s75, s67, 172032
    s_add_u32 s75, s75, s69
    buffer_load_dwordx4 v14, s[8:11], s75 offen lds
    s_mul_i32 s61, s84, 28
    s_lshr_b32 s62, s61, 6
    s_lshl_b32 s62, 1, s62
    s_add_u32 s61, s61, 27
    s_lshr_b32 s61, s61, 6
    s_bitset1_b32 s62, s61
    s_mul_i32 s48, s62, 0x10001
    s_mov_b32 s49, s48
    s_lshl_b32 s50, s48, 7
    s_lshl_b32 s51, s62, 7
    s_cmp_eq_u32 s3, 3
    s_mov_b32 s61, 0x01400140
    s_cselect_b32 s54, 0x01c001c0, s61
    s_cmp_eq_u32 s59, 7
    s_cselect_b32 s94, 0, 0x003c003c
    s_mov_b32 s95, 0
    s_cselect_b32 s52, 0, 0x00030003
    s_mov_b32 s55, 0
    s_mov_b32 s53, 0
    s_lshl_b32 s61, s3, 2
    s_lshl_b32 s92, 0x000f000f, s61
    s_mov_b32 s93, 0
    buffer_load_dwordx4 v15, s[8:11], s75 offen offset:1024 lds
    s_add_u32 s67, s67, 1
    s_cmp_eq_u32 s67, 7
    s_cselect_b32 s67, 0, s67
    s_add_u32 m0, s73, 32768
    s_mul_i32 s75, s67, 172032
    s_add_u32 s75, s75, s69
    buffer_load_dwordx4 v14, s[8:11], s75 offen lds
    buffer_load_dwordx4 v15, s[8:11], s75 offen offset:1024 lds
    s_add_u32 s67, s67, 1
    s_cmp_eq_u32 s67, 7
    s_cselect_b32 s67, 0, s67
    s_add_u32 m0, s73, 40960
    s_mul_i32 s75, s67, 172032
    s_add_u32 s75, s75, s69
    buffer_load_dwordx4 v14, s[8:11], s75 offen lds
    buffer_load_dwordx4 v15, s[8:11], s75 offen offset:1024 lds
    s_add_u32 s67, s67, 1
    s_cmp_eq_u32 s67, 7
    s_cselect_b32 s67, 0, s67
    s_add_u32 m0, s73, 49152
    s_mul_i32 s75, s67, 172032
    s_add_u32 s75, s75, s69
    buffer_load_dwordx4 v14, s[8:11], s75 offen lds
    buffer_load_dwordx4 v15, s[8:11], s75 offen offset:1024 lds
    s_add_u32 s67, s67, 1
    s_cmp_eq_u32 s67, 7
    s_cselect_b32 s67, 0, s67
    s_waitcnt vmcnt(25)
    s_barrier
    ds_read_b128 a[0:3], v21 offset:0
    ds_read_b64_tr_b16 v[156:157], v25 offset:0
    ds_read_b64_tr_b16 v[158:159], v25 offset:512
    ds_read_b64_tr_b16 v[160:161], v26 offset:0
    ds_read_b64_tr_b16 v[162:163], v26 offset:512
    ds_read_b128 a[4:7], v22 offset:0
    ds_read_b64_tr_b16 v[164:165], v25 offset:2048
    ds_read_b64_tr_b16 v[166:167], v25 offset:2560
    ds_read_b64_tr_b16 v[168:169], v26 offset:2048
    ds_read_b64_tr_b16 v[170:171], v26 offset:2560
    ds_read_b128 a[8:11], v23 offset:0
    ds_read_b64_tr_b16 v[172:173], v25 offset:4096
    ds_read_b64_tr_b16 v[174:175], v25 offset:4608
    ds_read_b64_tr_b16 v[176:177], v26 offset:4096
    ds_read_b64_tr_b16 v[178:179], v26 offset:4608
    ds_read_b128 a[12:15], v24 offset:0
    ds_read_b64_tr_b16 v[180:181], v25 offset:6144
    ds_read_b64_tr_b16 v[182:183], v25 offset:6656
    ds_read_b64_tr_b16 v[184:185], v26 offset:6144
    ds_read_b64_tr_b16 v[186:187], v26 offset:6656
    s_waitcnt lgkmcnt(10)
    v_mfma_f32_32x32x16_bf16 v[60:75], a[0:3], v[156:159], 0
    v_mfma_f32_32x32x16_bf16 v[76:91], a[0:3], v[160:163], 0
    s_waitcnt vmcnt(18) lgkmcnt(0)
    s_barrier
    ds_read_b128 a[16:19], v21 offset:16384
    ds_read_b64_tr_b16 v[188:189], v25 offset:8192
    ds_read_b64_tr_b16 v[190:191], v25 offset:8704
    ds_read_b64_tr_b16 v[192:193], v26 offset:8192
    s_add_u32 m0, s72, 0
    s_lshl_b32 s74, s66, 7
    s_add_u32 s74, s74, s68
    buffer_load_dwordx4 v10, s[4:7], s74 offen offset:0 lds
    v_mfma_f32_32x32x16_bf16 v[60:75], a[4:7], v[164:167], v[60:75]
    ds_read_b64_tr_b16 v[194:195], v26 offset:8704
    ds_read_b128 a[20:23], v22 offset:16384
    ds_read_b64_tr_b16 v[196:197], v25 offset:10240
    buffer_load_dwordx4 v11, s[4:7], s74 offen offset:1024 lds
    v_mfma_f32_32x32x16_bf16 v[76:91], a[4:7], v[168:171], v[76:91]
    ds_read_b64_tr_b16 v[198:199], v25 offset:10752
    ds_read_b64_tr_b16 v[200:201], v26 offset:10240
    ds_read_b64_tr_b16 v[202:203], v26 offset:10752
    buffer_load_dwordx4 v12, s[4:7], s74 offen offset:2048 lds
    v_mfma_f32_32x32x16_bf16 v[60:75], a[8:11], v[172:175], v[60:75]
    ds_read_b128 a[24:27], v23 offset:16384
    ds_read_b64_tr_b16 v[204:205], v25 offset:12288
    ds_read_b64_tr_b16 v[206:207], v25 offset:12800
    buffer_load_dwordx4 v13, s[4:7], s74 offen offset:3072 lds
    s_add_u32 s66, s66, 1
    s_cmp_eq_u32 s66, 7
    s_cselect_b32 s66, 0, s66
    v_mfma_f32_32x32x16_bf16 v[76:91], a[8:11], v[176:179], v[76:91]
    ds_read_b64_tr_b16 v[208:209], v26 offset:12288
    ds_read_b64_tr_b16 v[210:211], v26 offset:12800
    ds_read_b128 a[28:31], v24 offset:16384
    v_mfma_f32_32x32x16_bf16 v[60:75], a[12:15], v[180:183], v[60:75]
    ds_read_b64_tr_b16 v[212:213], v25 offset:14336
    ds_read_b64_tr_b16 v[214:215], v25 offset:14848
    v_mfma_f32_32x32x16_bf16 v[76:91], a[12:15], v[184:187], v[76:91]
    ds_read_b64_tr_b16 v[216:217], v26 offset:14336
    ds_read_b64_tr_b16 v[218:219], v26 offset:14848
    s_waitcnt lgkmcnt(10)
    v_mfma_f32_32x32x16_bf16 v[60:75], a[16:19], v[188:191], v[60:75]
    v_mfma_f32_32x32x16_bf16 v[76:91], a[16:19], v[192:195], v[76:91]
    s_waitcnt vmcnt(16) lgkmcnt(0)
    s_barrier
    ds_read_b128 a[32:35], v21 offset:32768
    ds_read_b64_tr_b16 v[156:157], v25 offset:16384
    ds_read_b64_tr_b16 v[158:159], v25 offset:16896
    ds_read_b64_tr_b16 v[160:161], v26 offset:16384
    s_add_u32 m0, s72, 16384
    s_lshl_b32 s74, s66, 7
    s_add_u32 s74, s74, s68
    buffer_load_dwordx4 v10, s[4:7], s74 offen offset:0 lds
    v_mfma_f32_32x32x16_bf16 v[60:75], a[20:23], v[196:199], v[60:75]
    ds_read_b64_tr_b16 v[162:163], v26 offset:16896
    ds_read_b128 a[36:39], v22 offset:32768
    ds_read_b64_tr_b16 v[164:165], v25 offset:18432
    buffer_load_dwordx4 v11, s[4:7], s74 offen offset:1024 lds
    v_mfma_f32_32x32x16_bf16 v[76:91], a[20:23], v[200:203], v[76:91]
    ds_read_b64_tr_b16 v[166:167], v25 offset:18944
    ds_read_b64_tr_b16 v[168:169], v26 offset:18432
    ds_read_b64_tr_b16 v[170:171], v26 offset:18944
    buffer_load_dwordx4 v12, s[4:7], s74 offen offset:2048 lds
    v_mfma_f32_32x32x16_bf16 v[60:75], a[24:27], v[204:207], v[60:75]
    ds_read_b128 a[40:43], v23 offset:32768
    ds_read_b64_tr_b16 v[172:173], v25 offset:20480
    ds_read_b64_tr_b16 v[174:175], v25 offset:20992
    buffer_load_dwordx4 v13, s[4:7], s74 offen offset:3072 lds
    s_add_u32 s66, s66, 1
    s_cmp_eq_u32 s66, 7
    s_cselect_b32 s66, 0, s66
    v_mfma_f32_32x32x16_bf16 v[76:91], a[24:27], v[208:211], v[76:91]
    ds_read_b64_tr_b16 v[176:177], v26 offset:20480
    ds_read_b64_tr_b16 v[178:179], v26 offset:20992
    ds_read_b128 a[44:47], v24 offset:32768
    v_mfma_f32_32x32x16_bf16 v[60:75], a[28:31], v[212:215], v[60:75]
    ds_read_b64_tr_b16 v[180:181], v25 offset:22528
    ds_read_b64_tr_b16 v[182:183], v25 offset:23040
    v_mfma_f32_32x32x16_bf16 v[76:91], a[28:31], v[216:219], v[76:91]
    ds_read_b64_tr_b16 v[184:185], v26 offset:22528
    ds_read_b64_tr_b16 v[186:187], v26 offset:23040
    s_waitcnt lgkmcnt(10)
    v_mfma_f32_32x32x16_bf16 v[60:75], a[32:35], v[156:159], v[60:75]
    s_mov_b32 s65, 393216
    s_mov_b64 exec, 0x3f
    buffer_load_dword v9, v29, s[28:31], s65 offen
    s_mov_b64 exec, -1
    s_lshl_b32 s75, s2, 2
    s_add_u32 s75, s75, s3
    s_mul_i32 s65, s75, 1664
    s_lshl_b32 s75, s75, 9
    v_lshlrev_b32 v3, 7, v6
    s_mov_b64 exec, 0x1fff
    buffer_load_dword v9, v3, s[12:15], s65 offen
    buffer_load_dword v9, v3, s[20:23], s65 offen
    s_mov_b64 exec, 15
    buffer_load_dword v9, v3, s[24:27], s75 offen
    s_mov_b64 exec, -1
    v_mfma_f32_32x32x16_bf16 v[76:91], a[32:35], v[160:163], v[76:91]
    s_waitcnt vmcnt(18) lgkmcnt(0)
    s_barrier
    ds_read_b128 a[48:51], v21 offset:49152
    ds_read_b64_tr_b16 v[188:189], v25 offset:24576
    ds_read_b64_tr_b16 v[190:191], v25 offset:25088
    ds_read_b64_tr_b16 v[192:193], v26 offset:24576
    s_add_u32 m0, s72, 32768
    s_lshl_b32 s74, s66, 7
    s_add_u32 s74, s74, s68
    buffer_load_dwordx4 v10, s[4:7], s74 offen offset:0 lds
    v_mfma_f32_32x32x16_bf16 v[60:75], a[36:39], v[164:167], v[60:75]
    ds_read_b64_tr_b16 v[194:195], v26 offset:25088
    ds_read_b128 a[52:55], v22 offset:49152
    ds_read_b64_tr_b16 v[196:197], v25 offset:26624
    buffer_load_dwordx4 v11, s[4:7], s74 offen offset:1024 lds
    v_mfma_f32_32x32x16_bf16 v[76:91], a[36:39], v[168:171], v[76:91]
    ds_read_b64_tr_b16 v[198:199], v25 offset:27136
    ds_read_b64_tr_b16 v[200:201], v26 offset:26624
    ds_read_b64_tr_b16 v[202:203], v26 offset:27136
    buffer_load_dwordx4 v12, s[4:7], s74 offen offset:2048 lds
    v_mfma_f32_32x32x16_bf16 v[60:75], a[40:43], v[172:175], v[60:75]
    ds_read_b128 a[56:59], v23 offset:49152
    ds_read_b64_tr_b16 v[204:205], v25 offset:28672
    ds_read_b64_tr_b16 v[206:207], v25 offset:29184
    buffer_load_dwordx4 v13, s[4:7], s74 offen offset:3072 lds
    s_add_u32 s66, s66, 1
    s_cmp_eq_u32 s66, 7
    s_cselect_b32 s66, 0, s66
    v_mfma_f32_32x32x16_bf16 v[76:91], a[40:43], v[176:179], v[76:91]
    ds_read_b64_tr_b16 v[208:209], v26 offset:28672
    ds_read_b64_tr_b16 v[210:211], v26 offset:29184
    ds_read_b128 a[60:63], v24 offset:49152
    v_mfma_f32_32x32x16_bf16 v[60:75], a[44:47], v[180:183], v[60:75]
    ds_read_b64_tr_b16 v[212:213], v25 offset:30720
    ds_read_b64_tr_b16 v[214:215], v25 offset:31232
    v_mfma_f32_32x32x16_bf16 v[76:91], a[44:47], v[184:187], v[76:91]
    ds_read_b64_tr_b16 v[216:217], v26 offset:30720
    ds_read_b64_tr_b16 v[218:219], v26 offset:31232
    s_waitcnt lgkmcnt(10)
    v_mfma_f32_32x32x16_bf16 v[60:75], a[48:51], v[188:191], v[60:75]
    v_mfma_f32_32x32x16_bf16 v[76:91], a[48:51], v[192:195], v[76:91]
    s_waitcnt vmcnt(12) lgkmcnt(0)
    s_barrier
    ds_read_b128 a[64:67], v21 offset:0
    ds_read_b64_tr_b16 v[156:157], v25 offset:32768
    ds_read_b64_tr_b16 v[158:159], v25 offset:33280
    ds_read_b64_tr_b16 v[160:161], v26 offset:32768
    s_add_u32 m0, s73, 0
    s_mul_i32 s75, s67, s80
    s_add_u32 s75, s75, s70
    buffer_load_dwordx4 v18, s[16:19], s75 offen lds
    v_mfma_f32_32x32x16_bf16 v[60:75], a[52:55], v[196:199], v[60:75]
    ds_read_b64_tr_b16 v[162:163], v26 offset:33280
    ds_read_b128 a[68:71], v22 offset:0
    ds_read_b64_tr_b16 v[164:165], v25 offset:34816
    buffer_load_dwordx4 v19, s[16:19], s75 offen offset:1024 lds
    s_add_u32 s67, s67, 1
    s_cmp_eq_u32 s67, 7
    s_cselect_b32 s67, 0, s67
    v_mfma_f32_32x32x16_bf16 v[76:91], a[52:55], v[200:203], v[76:91]
    ds_read_b64_tr_b16 v[166:167], v25 offset:35328
    ds_read_b64_tr_b16 v[168:169], v26 offset:34816
    ds_read_b64_tr_b16 v[170:171], v26 offset:35328
    s_add_u32 m0, s73, 8192
    s_mul_i32 s75, s67, s80
    s_add_u32 s75, s75, s70
    buffer_load_dwordx4 v18, s[16:19], s75 offen lds
    v_mfma_f32_32x32x16_bf16 v[60:75], a[56:59], v[204:207], v[60:75]
    ds_read_b128 a[72:75], v23 offset:0
    ds_read_b64_tr_b16 v[172:173], v25 offset:36864
    ds_read_b64_tr_b16 v[174:175], v25 offset:37376
    buffer_load_dwordx4 v19, s[16:19], s75 offen offset:1024 lds
    s_add_u32 s67, s67, 1
    s_cmp_eq_u32 s67, 7
    s_cselect_b32 s67, 0, s67
    v_mfma_f32_32x32x16_bf16 v[76:91], a[56:59], v[208:211], v[76:91]
    ds_read_b64_tr_b16 v[176:177], v26 offset:36864
    ds_read_b64_tr_b16 v[178:179], v26 offset:37376
    ds_read_b128 a[76:79], v24 offset:0
    v_mfma_f32_32x32x16_bf16 v[60:75], a[60:63], v[212:215], v[60:75]
    ds_read_b64_tr_b16 v[180:181], v25 offset:38912
    ds_read_b64_tr_b16 v[182:183], v25 offset:39424
    v_mfma_f32_32x32x16_bf16 v[76:91], a[60:63], v[216:219], v[76:91]
    ds_read_b64_tr_b16 v[184:185], v26 offset:38912
    ds_read_b64_tr_b16 v[186:187], v26 offset:39424
    v_add_u32 v20, 0x9e3779b9, v20
    s_waitcnt lgkmcnt(10)
    v_mfma_f32_32x32x16_bf16 v[60:75], a[64:67], v[156:159], v[60:75]
    v_mfma_f32_32x32x16_bf16 v[76:91], a[64:67], v[160:163], v[76:91]
    s_waitcnt vmcnt(12) lgkmcnt(0)
    s_barrier
    ds_read_b128 a[80:83], v21 offset:16384
    ds_read_b64_tr_b16 v[188:189], v25 offset:40960
    ds_read_b64_tr_b16 v[190:191], v25 offset:41472
    ds_read_b64_tr_b16 v[192:193], v26 offset:40960
    s_add_u32 m0, s73, 16384
    s_mul_i32 s75, s67, s80
    s_add_u32 s75, s75, s70
    buffer_load_dwordx4 v18, s[16:19], s75 offen lds
    v_mfma_f32_32x32x16_bf16 v[60:75], a[68:71], v[164:167], v[60:75]
    ds_read_b64_tr_b16 v[194:195], v26 offset:41472
    ds_read_b128 a[84:87], v22 offset:16384
    ds_read_b64_tr_b16 v[196:197], v25 offset:43008
    buffer_load_dwordx4 v19, s[16:19], s75 offen offset:1024 lds
    s_add_u32 s67, s67, 1
    s_cmp_eq_u32 s67, 7
    s_cselect_b32 s67, 0, s67
    v_mfma_f32_32x32x16_bf16 v[76:91], a[68:71], v[168:171], v[76:91]
    ds_read_b64_tr_b16 v[198:199], v25 offset:43520
    ds_read_b64_tr_b16 v[200:201], v26 offset:43008
    ds_read_b64_tr_b16 v[202:203], v26 offset:43520
    s_add_u32 m0, s73, 24576
    s_mul_i32 s75, s67, s80
    s_add_u32 s75, s75, s70
    buffer_load_dwordx4 v18, s[16:19], s75 offen lds
    v_mfma_f32_32x32x16_bf16 v[60:75], a[72:75], v[172:175], v[60:75]
    ds_read_b128 a[88:91], v23 offset:16384
    ds_read_b64_tr_b16 v[204:205], v25 offset:45056
    ds_read_b64_tr_b16 v[206:207], v25 offset:45568
    buffer_load_dwordx4 v19, s[16:19], s75 offen offset:1024 lds
    s_add_u32 s67, s67, 1
    s_cmp_eq_u32 s67, 7
    s_cselect_b32 s67, 0, s67
    v_mfma_f32_32x32x16_bf16 v[76:91], a[72:75], v[176:179], v[76:91]
    ds_read_b64_tr_b16 v[208:209], v26 offset:45056
    ds_read_b64_tr_b16 v[210:211], v26 offset:45568
    ds_read_b128 a[92:95], v24 offset:16384
    v_mfma_f32_32x32x16_bf16 v[60:75], a[76:79], v[180:183], v[60:75]
    ds_read_b64_tr_b16 v[212:213], v25 offset:47104
    ds_read_b64_tr_b16 v[214:215], v25 offset:47616
    v_mfma_f32_32x32x16_bf16 v[76:91], a[76:79], v[184:187], v[76:91]
    ds_read_b64_tr_b16 v[216:217], v26 offset:47104
    ds_read_b64_tr_b16 v[218:219], v26 offset:47616
    s_waitcnt lgkmcnt(10)
    v_mfma_f32_32x32x16_bf16 v[60:75], a[80:83], v[188:191], v[60:75]
    v_mfma_f32_32x32x16_bf16 v[76:91], a[80:83], v[192:195], v[76:91]
    s_waitcnt vmcnt(8) lgkmcnt(0)
    s_barrier
    ds_read_b128 a[96:99], v21 offset:32768
    ds_read_b64_tr_b16 v[156:157], v25 offset:49152
    ds_read_b64_tr_b16 v[158:159], v25 offset:49664
    ds_read_b64_tr_b16 v[160:161], v26 offset:49152
    s_add_u32 m0, s73, 32768
    s_mul_i32 s75, s67, s80
    s_add_u32 s75, s75, s70
    buffer_load_dwordx4 v18, s[16:19], s75 offen lds
    v_mfma_f32_32x32x16_bf16 v[60:75], a[84:87], v[196:199], v[60:75]
    ds_read_b64_tr_b16 v[162:163], v26 offset:49664
    ds_read_b128 a[100:103], v22 offset:32768
    ds_read_b64_tr_b16 v[164:165], v25 offset:51200
    buffer_load_dwordx4 v19, s[16:19], s75 offen offset:1024 lds
    s_add_u32 s67, s67, 1
    s_cmp_eq_u32 s67, 7
    s_cselect_b32 s67, 0, s67
    v_mfma_f32_32x32x16_bf16 v[76:91], a[84:87], v[200:203], v[76:91]
    ds_read_b64_tr_b16 v[166:167], v25 offset:51712
    ds_read_b64_tr_b16 v[168:169], v26 offset:51200
    ds_read_b64_tr_b16 v[170:171], v26 offset:51712
    s_add_u32 m0, s73, 40960
    s_mul_i32 s75, s67, s80
    s_add_u32 s75, s75, s70
    buffer_load_dwordx4 v18, s[16:19], s75 offen lds
    v_mfma_f32_32x32x16_bf16 v[60:75], a[88:91], v[204:207], v[60:75]
    ds_read_b128 a[104:107], v23 offset:32768
    ds_read_b64_tr_b16 v[172:173], v25 offset:53248
    ds_read_b64_tr_b16 v[174:175], v25 offset:53760
    buffer_load_dwordx4 v19, s[16:19], s75 offen offset:1024 lds
    s_add_u32 s67, s67, 1
    s_cmp_eq_u32 s67, 7
    s_cselect_b32 s67, 0, s67
    v_mfma_f32_32x32x16_bf16 v[76:91], a[88:91], v[208:211], v[76:91]
    ds_read_b64_tr_b16 v[176:177], v26 offset:53248
    ds_read_b64_tr_b16 v[178:179], v26 offset:53760
    ds_read_b128 a[108:111], v24 offset:32768
    v_mfma_f32_32x32x16_bf16 v[60:75], a[92:95], v[212:215], v[60:75]
    ds_read_b64_tr_b16 v[180:181], v25 offset:55296
    ds_read_b64_tr_b16 v[182:183], v25 offset:55808
    v_mfma_f32_32x32x16_bf16 v[76:91], a[92:95], v[216:219], v[76:91]
    ds_read_b64_tr_b16 v[184:185], v26 offset:55296
    ds_read_b64_tr_b16 v[186:187], v26 offset:55808
    s_waitcnt lgkmcnt(10)
    v_mfma_f32_32x32x16_bf16 v[60:75], a[96:99], v[156:159], v[60:75]
    v_mfma_f32_32x32x16_bf16 v[76:91], a[96:99], v[160:163], v[76:91]
    s_waitcnt vmcnt(8) lgkmcnt(0)
    s_barrier
    ds_read_b64_tr_b16 v[188:189], v25 offset:0
    ds_read_b64_tr_b16 v[190:191], v25 offset:512
    ds_read_b64_tr_b16 v[192:193], v26 offset:0
    ds_read_b64_tr_b16 v[194:195], v26 offset:512
    s_add_u32 m0, s73, 49152
    s_mul_i32 s75, s67, s80
    s_add_u32 s75, s75, s70
    buffer_load_dwordx4 v18, s[16:19], s75 offen lds
    v_mfma_f32_32x32x16_bf16 v[60:75], a[100:103], v[164:167], v[60:75]
    ds_read_b64_tr_b16 v[196:197], v25 offset:2048
    ds_read_b64_tr_b16 v[198:199], v25 offset:2560
    ds_read_b64_tr_b16 v[200:201], v26 offset:2048
    buffer_load_dwordx4 v19, s[16:19], s75 offen offset:1024 lds
    s_add_u32 s67, s67, 1
    s_cmp_eq_u32 s67, 7
    s_cselect_b32 s67, 0, s67
    v_mfma_f32_32x32x16_bf16 v[76:91], a[100:103], v[168:171], v[76:91]
    ds_read_b64_tr_b16 v[202:203], v26 offset:2560
    v_mfma_f32_32x32x16_bf16 v[60:75], a[104:107], v[172:175], v[60:75]
    ds_read_b64_tr_b16 v[204:205], v25 offset:4096
    ds_read_b64_tr_b16 v[206:207], v25 offset:4608
    ds_read_b64_tr_b16 v[208:209], v26 offset:4096
    v_mfma_f32_32x32x16_bf16 v[76:91], a[104:107], v[176:179], v[76:91]
    ds_read_b64_tr_b16 v[210:211], v26 offset:4608
    ds_read_b64_tr_b16 v[212:213], v25 offset:6144
    ds_read_b64_tr_b16 v[214:215], v25 offset:6656
    v_mfma_f32_32x32x16_bf16 v[60:75], a[108:111], v[180:183], v[60:75]
    ds_read_b64_tr_b16 v[216:217], v26 offset:6144
    ds_read_b64_tr_b16 v[218:219], v26 offset:6656
    v_mfma_f32_32x32x16_bf16 v[76:91], a[108:111], v[184:187], v[76:91]
    s_cmp_eq_u32 s59, 7
    s_cbranch_scc1 L_heavy
    s_cmp_lt_u32 s76, 3
    s_cbranch_scc1 L_qq
    s_waitcnt lgkmcnt(8)
    v_mfma_f32_32x32x16_bf16 v[124:139], v[188:191], a[0:3], 0
    ds_read_b64_tr_b16 v[156:157], v25 offset:8192
    ds_read_b64_tr_b16 v[158:159], v25 offset:8704
    ds_read_b64_tr_b16 v[160:161], v26 offset:8192
    s_cmp_lt_u32 s57, 7
    s_cselect_b32 s86, 0x3e8b97f6, 1.0
    s_mov_b32 s87, s86
    s_mul_i32 s63, s60, 86016
    s_lshl_b32 s64, s57, 10
    s_add_u32 s63, s63, s64
    s_add_u32 s63, s63, 1048576
    s_add_u32 s64, s63, 43008
    v_pk_mul_f32 v[60:61], v[60:61], s[86:87]
    v_pk_mul_f32 v[62:63], v[62:63], s[86:87]
    v_mfma_f32_32x32x16_bf16 v[140:155], v[192:195], a[0:3], 0
    ds_read_b64_tr_b16 v[162:163], v26 offset:8704
    ds_read_b64_tr_b16 v[164:165], v25 offset:10240
    ds_read_b64_tr_b16 v[166:167], v25 offset:10752
    v_pk_mul_f32 v[64:65], v[64:65], s[86:87]
    v_pk_mul_f32 v[66:67], v[66:67], s[86:87]
    v_cvt_pk_bf16_f32 v220, v60, v61
    v_cvt_pk_bf16_f32 v221, v62, v63
    v_mfma_f32_32x32x16_bf16 v[124:139], v[196:199], a[4:7], v[124:139]
    ds_read_b64_tr_b16 v[168:169], v26 offset:10240
    ds_read_b64_tr_b16 v[170:171], v26 offset:10752
    v_cvt_pk_bf16_f32 v222, v64, v65
    v_cvt_pk_bf16_f32 v223, v66, v67
    buffer_store_dwordx4 v[220:223], v28, s[28:31], s63 offen offset:0 sc1
    v_pk_mul_f32 v[68:69], v[68:69], s[86:87]
    v_mfma_f32_32x32x16_bf16 v[140:155], v[200:203], a[4:7], v[140:155]
    v_pk_mul_f32 v[70:71], v[70:71], s[86:87]
    v_pk_mul_f32 v[72:73], v[72:73], s[86:87]
    v_pk_mul_f32 v[74:75], v[74:75], s[86:87]
    v_cvt_pk_bf16_f32 v224, v68, v69
    s_waitcnt lgkmcnt(8)
    v_mfma_f32_32x32x16_bf16 v[124:139], v[204:207], a[8:11], v[124:139]
    ds_read_b64_tr_b16 v[172:173], v25 offset:12288
    ds_read_b64_tr_b16 v[174:175], v25 offset:12800
    ds_read_b64_tr_b16 v[176:177], v26 offset:12288
    v_cvt_pk_bf16_f32 v225, v70, v71
    v_cvt_pk_bf16_f32 v226, v72, v73
    v_cvt_pk_bf16_f32 v227, v74, v75
    buffer_store_dwordx4 v[224:227], v28, s[28:31], s64 offen offset:0 sc1
    v_mfma_f32_32x32x16_bf16 v[140:155], v[208:211], a[8:11], v[140:155]
    ds_read_b64_tr_b16 v[178:179], v26 offset:12800
    ds_read_b64_tr_b16 v[180:181], v25 offset:14336
    ds_read_b64_tr_b16 v[182:183], v25 offset:14848
    v_pk_mul_f32 v[76:77], v[76:77], s[86:87]
    v_pk_mul_f32 v[78:79], v[78:79], s[86:87]
    v_pk_mul_f32 v[80:81], v[80:81], s[86:87]
    v_pk_mul_f32 v[82:83], v[82:83], s[86:87]
    v_mfma_f32_32x32x16_bf16 v[124:139], v[212:215], a[12:15], v[124:139]
    ds_read_b64_tr_b16 v[184:185], v26 offset:14336
    ds_read_b64_tr_b16 v[186:187], v26 offset:14848
    v_cvt_pk_bf16_f32 v228, v76, v77
    v_cvt_pk_bf16_f32 v229, v78, v79
    v_cvt_pk_bf16_f32 v230, v80, v81
    v_cvt_pk_bf16_f32 v231, v82, v83
    v_mfma_f32_32x32x16_bf16 v[140:155], v[216:219], a[12:15], v[140:155]
    buffer_store_dwordx4 v[228:231], v28, s[28:31], s63 offen offset:512 sc1
    v_pk_mul_f32 v[84:85], v[84:85], s[86:87]
    v_pk_mul_f32 v[86:87], v[86:87], s[86:87]
    v_pk_mul_f32 v[88:89], v[88:89], s[86:87]
    s_waitcnt lgkmcnt(8)
    v_mfma_f32_32x32x16_bf16 v[124:139], v[156:159], a[16:19], v[124:139]
    v_pk_mul_f32 v[90:91], v[90:91], s[86:87]
    v_cvt_pk_bf16_f32 v232, v84, v85
    v_cvt_pk_bf16_f32 v233, v86, v87
    v_cvt_pk_bf16_f32 v234, v88, v89
    v_mfma_f32_32x32x16_bf16 v[140:155], v[160:163], a[16:19], v[140:155]
    s_waitcnt vmcnt(9) lgkmcnt(0)
    s_barrier
    ds_read_b64_tr_b16 v[188:189], v25 offset:16384
    ds_read_b64_tr_b16 v[190:191], v25 offset:16896
    ds_read_b64_tr_b16 v[192:193], v26 offset:16384
    ds_read_b64_tr_b16 v[194:195], v26 offset:16896
    s_mul_i32 s71, s3, 57344
    s_lshl_b32 s75, s78, 7
    s_add_u32 s71, s71, s75
    s_add_u32 m0, s73, 0
    s_mul_i32 s75, s67, 229376
    s_add_u32 s75, s75, s71
    buffer_load_dwordx4 v16, s[12:15], s75 offen lds
    v_cvt_pk_bf16_f32 v235, v90, v91
    buffer_store_dwordx4 v[232:235], v28, s[28:31], s64 offen offset:512 sc1
    v_mfma_f32_32x32x16_bf16 v[124:139], v[164:167], a[20:23], v[124:139]
    ds_read_b64_tr_b16 v[196:197], v25 offset:18432
    ds_read_b64_tr_b16 v[198:199], v25 offset:18944
    ds_read_b64_tr_b16 v[200:201], v26 offset:18432
    v_mfma_f32_32x32x16_bf16 v[140:155], v[168:171], a[20:23], v[140:155]
    ds_read_b64_tr_b16 v[202:203], v26 offset:18944
    buffer_load_dwordx4 v17, s[12:15], s75 offen offset:1024 lds
    s_add_u32 s67, s67, 1
    s_cmp_eq_u32 s67, 7
    s_cselect_b32 s67, 0, s67
    v_mfma_f32_32x32x16_bf16 v[124:139], v[172:175], a[24:27], v[124:139]
    ds_read_b64_tr_b16 v[204:205], v25 offset:20480
    ds_read_b64_tr_b16 v[206:207], v25 offset:20992
    ds_read_b64_tr_b16 v[208:209], v26 offset:20480
    v_mfma_f32_32x32x16_bf16 v[140:155], v[176:179], a[24:27], v[140:155]
    ds_read_b64_tr_b16 v[210:211], v26 offset:20992
    ds_read_b64_tr_b16 v[212:213], v25 offset:22528
    ds_read_b64_tr_b16 v[214:215], v25 offset:23040
    s_add_u32 m0, s73, 8192
    s_mul_i32 s75, s67, 229376
    s_add_u32 s75, s75, s71
    buffer_load_dwordx4 v16, s[12:15], s75 offen lds
    v_mfma_f32_32x32x16_bf16 v[124:139], v[180:183], a[28:31], v[124:139]
    ds_read_b64_tr_b16 v[216:217], v26 offset:22528
    ds_read_b64_tr_b16 v[218:219], v26 offset:23040
    v_mfma_f32_32x32x16_bf16 v[140:155], v[184:187], a[28:31], v[140:155]
    buffer_load_dwordx4 v17, s[12:15], s75 offen offset:1024 lds
    s_add_u32 s67, s67, 1
    s_cmp_eq_u32 s67, 7
    s_cselect_b32 s67, 0, s67
    s_waitcnt lgkmcnt(8)
    v_mfma_f32_32x32x16_bf16 v[124:139], v[188:191], a[32:35], v[124:139]
    ds_read_b64_tr_b16 v[156:157], v25 offset:24576
    ds_read_b64_tr_b16 v[158:159], v25 offset:25088
    ds_read_b64_tr_b16 v[160:161], v26 offset:24576
    v_mfma_f32_32x32x16_bf16 v[140:155], v[192:195], a[32:35], v[140:155]
    ds_read_b64_tr_b16 v[162:163], v26 offset:25088
    ds_read_b64_tr_b16 v[164:165], v25 offset:26624
    ds_read_b64_tr_b16 v[166:167], v25 offset:27136
    v_mfma_f32_32x32x16_bf16 v[124:139], v[196:199], a[36:39], v[124:139]
    ds_read_b64_tr_b16 v[168:169], v26 offset:26624
    ds_read_b64_tr_b16 v[170:171], v26 offset:27136
    v_mfma_f32_32x32x16_bf16 v[140:155], v[200:203], a[36:39], v[140:155]
    s_waitcnt lgkmcnt(8)
    v_mfma_f32_32x32x16_bf16 v[124:139], v[204:207], a[40:43], v[124:139]
    ds_read_b64_tr_b16 v[172:173], v25 offset:28672
    ds_read_b64_tr_b16 v[174:175], v25 offset:29184
    ds_read_b64_tr_b16 v[176:177], v26 offset:28672
    v_mfma_f32_32x32x16_bf16 v[140:155], v[208:211], a[40:43], v[140:155]
    ds_read_b64_tr_b16 v[178:179], v26 offset:29184
    ds_read_b64_tr_b16 v[180:181], v25 offset:30720
    ds_read_b64_tr_b16 v[182:183], v25 offset:31232
    v_mfma_f32_32x32x16_bf16 v[124:139], v[212:215], a[44:47], v[124:139]
    ds_read_b64_tr_b16 v[184:185], v26 offset:30720
    ds_read_b64_tr_b16 v[186:187], v26 offset:31232
    v_mfma_f32_32x32x16_bf16 v[140:155], v[216:219], a[44:47], v[140:155]
    s_waitcnt lgkmcnt(8)
    v_mfma_f32_32x32x16_bf16 v[124:139], v[156:159], a[48:51], v[124:139]
    v_mfma_f32_32x32x16_bf16 v[140:155], v[160:163], a[48:51], v[140:155]
    s_waitcnt vmcnt(10) lgkmcnt(0)
    s_barrier
    ds_read_b64_tr_b16 v[188:189], v25 offset:32768
    ds_read_b64_tr_b16 v[190:191], v25 offset:33280
    ds_read_b64_tr_b16 v[192:193], v26 offset:32768
    ds_read_b64_tr_b16 v[194:195], v26 offset:33280
    s_add_u32 m0, s73, 16384
    s_mul_i32 s75, s67, 229376
    s_add_u32 s75, s75, s71
    buffer_load_dwordx4 v16, s[12:15], s75 offen lds
    v_mfma_f32_32x32x16_bf16 v[124:139], v[164:167], a[52:55], v[124:139]
    ds_read_b64_tr_b16 v[196:197], v25 offset:34816
    ds_read_b64_tr_b16 v[198:199], v25 offset:35328
    ds_read_b64_tr_b16 v[200:201], v26 offset:34816
    v_mfma_f32_32x32x16_bf16 v[140:155], v[168:171], a[52:55], v[140:155]
    ds_read_b64_tr_b16 v[202:203], v26 offset:35328
    buffer_load_dwordx4 v17, s[12:15], s75 offen offset:1024 lds
    s_add_u32 s67, s67, 1
    s_cmp_eq_u32 s67, 7
    s_cselect_b32 s67, 0, s67
    v_mfma_f32_32x32x16_bf16 v[124:139], v[172:175], a[56:59], v[124:139]
    ds_read_b64_tr_b16 v[204:205], v25 offset:36864
    ds_read_b64_tr_b16 v[206:207], v25 offset:37376
    ds_read_b64_tr_b16 v[208:209], v26 offset:36864
    v_mfma_f32_32x32x16_bf16 v[140:155], v[176:179], a[56:59], v[140:155]
    ds_read_b64_tr_b16 v[210:211], v26 offset:37376
    ds_read_b64_tr_b16 v[212:213], v25 offset:38912
    ds_read_b64_tr_b16 v[214:215], v25 offset:39424
    s_add_u32 m0, s73, 24576
    s_mul_i32 s75, s67, 229376
    s_add_u32 s75, s75, s71
    buffer_load_dwordx4 v16, s[12:15], s75 offen lds
    v_mfma_f32_32x32x16_bf16 v[124:139], v[180:183], a[60:63], v[124:139]
    ds_read_b64_tr_b16 v[216:217], v26 offset:38912
    ds_read_b64_tr_b16 v[218:219], v26 offset:39424
    v_mfma_f32_32x32x16_bf16 v[140:155], v[184:187], a[60:63], v[140:155]
    buffer_load_dwordx4 v17, s[12:15], s75 offen offset:1024 lds
    s_add_u32 s67, s67, 1
    s_cmp_eq_u32 s67, 7
    s_cselect_b32 s67, 0, s67
    s_waitcnt lgkmcnt(8)
    v_mfma_f32_32x32x16_bf16 v[124:139], v[188:191], a[64:67], v[124:139]
    ds_read_b64_tr_b16 v[156:157], v25 offset:40960
    ds_read_b64_tr_b16 v[158:159], v25 offset:41472
    ds_read_b64_tr_b16 v[160:161], v26 offset:40960
    v_mfma_f32_32x32x16_bf16 v[140:155], v[192:195], a[64:67], v[140:155]
    ds_read_b64_tr_b16 v[162:163], v26 offset:41472
    ds_read_b64_tr_b16 v[164:165], v25 offset:43008
    ds_read_b64_tr_b16 v[166:167], v25 offset:43520
    v_mfma_f32_32x32x16_bf16 v[124:139], v[196:199], a[68:71], v[124:139]
    ds_read_b64_tr_b16 v[168:169], v26 offset:43008
    ds_read_b64_tr_b16 v[170:171], v26 offset:43520
    v_mfma_f32_32x32x16_bf16 v[140:155], v[200:203], a[68:71], v[140:155]
    s_waitcnt lgkmcnt(8)
    v_mfma_f32_32x32x16_bf16 v[124:139], v[204:207], a[72:75], v[124:139]
    ds_read_b64_tr_b16 v[172:173], v25 offset:45056
    ds_read_b64_tr_b16 v[174:175], v25 offset:45568
    ds_read_b64_tr_b16 v[176:177], v26 offset:45056
    v_mfma_f32_32x32x16_bf16 v[140:155], v[208:211], a[72:75], v[140:155]
    ds_read_b64_tr_b16 v[178:179], v26 offset:45568
    ds_read_b64_tr_b16 v[180:181], v25 offset:47104
    ds_read_b64_tr_b16 v[182:183], v25 offset:47616
    s_add_u32 m0, s45, 0
    s_nop 0
    buffer_load_dwordx4 v37, s[20:23], s36 offen offset:0 lds
    v_mfma_f32_32x32x16_bf16 v[124:139], v[212:215], a[76:79], v[124:139]
    ds_read_b64_tr_b16 v[184:185], v26 offset:47104
    ds_read_b64_tr_b16 v[186:187], v26 offset:47616
    v_mfma_f32_32x32x16_bf16 v[140:155], v[216:219], a[76:79], v[140:155]
    buffer_load_dwordx4 v38, s[20:23], s36 offen offset:1024 lds
    s_waitcnt lgkmcnt(8)
    v_mfma_f32_32x32x16_bf16 v[124:139], v[156:159], a[80:83], v[124:139]
    v_mfma_f32_32x32x16_bf16 v[140:155], v[160:163], a[80:83], v[140:155]
    s_waitcnt vmcnt(14) lgkmcnt(0)
    s_barrier
    ds_read_b64_tr_b16 v[188:189], v25 offset:49152
    ds_read_b64_tr_b16 v[190:191], v25 offset:49664
    ds_read_b64_tr_b16 v[192:193], v26 offset:49152
    ds_read_b64_tr_b16 v[194:195], v26 offset:49664
    buffer_load_dwordx4 v39, s[20:23], s36 offen offset:2048 lds
    v_mfma_f32_32x32x16_bf16 v[124:139], v[164:167], a[84:87], v[124:139]
    ds_read_b64_tr_b16 v[196:197], v25 offset:51200
    ds_read_b64_tr_b16 v[198:199], v25 offset:51712
    ds_read_b64_tr_b16 v[200:201], v26 offset:51200
    buffer_load_dwordx4 v40, s[20:23], s36 offen offset:3072 lds
    s_add_u32 s36, s36, 28672
    s_cmp_eq_u32 s36, s38
    s_cselect_b32 s36, s37, s36
    v_mfma_f32_32x32x16_bf16 v[140:155], v[168:171], a[84:87], v[140:155]
    ds_read_b64_tr_b16 v[202:203], v26 offset:51712
    s_add_u32 m0, s45, 4096
    s_nop 0
    buffer_load_dwordx4 v37, s[20:23], s36 offen offset:0 lds
    s_waitcnt vmcnt(12)
    s_mov_b32 s61, 393216
    s_mov_b64 exec, 1
    buffer_store_dword v20, v29, s[28:31], s61 offen sc1
    s_mov_b64 exec, -1
    v_mfma_f32_32x32x16_bf16 v[124:139], v[172:175], a[88:91], v[124:139]
    ds_read_b64_tr_b16 v[204:205], v25 offset:53248
    ds_read_b64_tr_b16 v[206:207], v25 offset:53760
    ds_read_b64_tr_b16 v[208:209], v26 offset:53248
    v_mfma_f32_32x32x16_bf16 v[140:155], v[176:179], a[88:91], v[140:155]
    ds_read_b64_tr_b16 v[210:211], v26 offset:53760
    ds_read_b64_tr_b16 v[212:213], v25 offset:55296
    ds_read_b64_tr_b16 v[214:215], v25 offset:55808
    buffer_load_dwordx4 v38, s[20:23], s36 offen offset:1024 lds
    v_mfma_f32_32x32x16_bf16 v[124:139], v[180:183], a[92:95], v[124:139]
    ds_read_b64_tr_b16 v[216:217], v26 offset:55296
    ds_read_b64_tr_b16 v[218:219], v26 offset:55808
    v_mfma_f32_32x32x16_bf16 v[140:155], v[184:187], a[92:95], v[140:155]
    buffer_load_dwordx4 v39, s[20:23], s36 offen offset:2048 lds
    s_waitcnt lgkmcnt(8)
    v_mfma_f32_32x32x16_bf16 v[124:139], v[188:191], a[96:99], v[124:139]
    v_mfma_f32_32x32x16_bf16 v[140:155], v[192:195], a[96:99], v[140:155]
    s_waitcnt vmcnt(12) lgkmcnt(0)
    s_barrier
    ds_read_b64_tr_b16 v[156:157], v25 offset:0
    ds_read_b64_tr_b16 v[158:159], v25 offset:512
    ds_read_b64_tr_b16 v[160:161], v26 offset:0
    ds_read_b64_tr_b16 v[162:163], v26 offset:512
    buffer_load_dwordx4 v40, s[20:23], s36 offen offset:3072 lds
    s_add_u32 s36, s36, 28672
    s_cmp_eq_u32 s36, s38
    s_cselect_b32 s36, s37, s36
    v_mfma_f32_32x32x16_bf16 v[124:139], v[196:199], a[100:103], v[124:139]
    ds_read_b64_tr_b16 v[164:165], v25 offset:2048
    ds_read_b64_tr_b16 v[166:167], v25 offset:2560
    ds_read_b64_tr_b16 v[168:169], v26 offset:2048
    v_mfma_f32_32x32x16_bf16 v[140:155], v[200:203], a[100:103], v[140:155]
    ds_read_b64_tr_b16 v[170:171], v26 offset:2560
    s_add_u32 m0, s73, 32768
    s_mul_i32 s75, s67, 229376
    s_add_u32 s75, s75, s71
    buffer_load_dwordx4 v16, s[12:15], s75 offen lds
    v_mfma_f32_32x32x16_bf16 v[124:139], v[204:207], a[104:107], v[124:139]
    ds_read_b64_tr_b16 v[172:173], v25 offset:4096
    ds_read_b64_tr_b16 v[174:175], v25 offset:4608
    ds_read_b64_tr_b16 v[176:177], v26 offset:4096
    v_mfma_f32_32x32x16_bf16 v[140:155], v[208:211], a[104:107], v[140:155]
    ds_read_b64_tr_b16 v[178:179], v26 offset:4608
    ds_read_b64_tr_b16 v[180:181], v25 offset:6144
    ds_read_b64_tr_b16 v[182:183], v25 offset:6656
    buffer_load_dwordx4 v17, s[12:15], s75 offen offset:1024 lds
    s_add_u32 s67, s67, 1
    s_cmp_eq_u32 s67, 7
    s_cselect_b32 s67, 0, s67
    v_mfma_f32_32x32x16_bf16 v[124:139], v[212:215], a[108:111], v[124:139]
    ds_read_b64_tr_b16 v[184:185], v26 offset:6144
    ds_read_b64_tr_b16 v[186:187], v26 offset:6656
    v_mfma_f32_32x32x16_bf16 v[140:155], v[216:219], a[108:111], v[140:155]
    s_add_u32 m0, s73, 40960
    s_mul_i32 s75, s67, 229376
    s_add_u32 s75, s75, s71
    buffer_load_dwordx4 v16, s[12:15], s75 offen lds
    s_waitcnt lgkmcnt(8)
    v_mfma_f32_32x32x16_bf16 v[92:107], v[156:159], a[0:3], 0
    ds_read_b64_tr_b16 v[188:189], v25 offset:8192
    ds_read_b64_tr_b16 v[190:191], v25 offset:8704
    ds_read_b64_tr_b16 v[192:193], v26 offset:8192
    v_cvt_pk_bf16_f32 v236, v124, v125
    v_cvt_pk_bf16_f32 v237, v126, v127
    v_cvt_pk_bf16_f32 v238, v128, v129
    v_cvt_pk_bf16_f32 v239, v130, v131
    v_mfma_f32_32x32x16_bf16 v[108:123], v[160:163], a[0:3], 0
    ds_read_b64_tr_b16 v[194:195], v26 offset:8704
    ds_read_b64_tr_b16 v[196:197], v25 offset:10240
    ds_read_b64_tr_b16 v[198:199], v25 offset:10752
    buffer_load_dwordx4 v17, s[12:15], s75 offen offset:1024 lds
    s_add_u32 s67, s67, 1
    s_cmp_eq_u32 s67, 7
    s_cselect_b32 s67, 0, s67
    v_pk_max_i16 v236, v236, 0
    v_pk_max_i16 v237, v237, 0
    v_pk_max_i16 v238, v238, 0
    v_pk_max_i16 v239, v239, 0
    v_mfma_f32_32x32x16_bf16 v[92:107], v[164:167], a[4:7], v[92:107]
    ds_read_b64_tr_b16 v[200:201], v26 offset:10240
    ds_read_b64_tr_b16 v[202:203], v26 offset:10752
    v_cvt_pk_bf16_f32 v240, v132, v133
    v_cvt_pk_bf16_f32 v241, v134, v135
    v_cvt_pk_bf16_f32 v242, v136, v137
    v_cvt_pk_bf16_f32 v243, v138, v139
    v_mfma_f32_32x32x16_bf16 v[108:123], v[168:171], a[4:7], v[108:123]
    s_add_u32 m0, s73, 49152
    s_mul_i32 s75, s67, 229376
    s_add_u32 s75, s75, s71
    buffer_load_dwordx4 v16, s[12:15], s75 offen lds
    v_pk_max_i16 v240, v240, 0
    v_pk_max_i16 v241, v241, 0
    v_pk_max_i16 v242, v242, 0
    v_pk_max_i16 v243, v243, 0
    s_waitcnt lgkmcnt(8)
    v_mfma_f32_32x32x16_bf16 v[92:107], v[172:175], a[8:11], v[92:107]
    ds_read_b64_tr_b16 v[204:205], v25 offset:12288
    ds_read_b64_tr_b16 v[206:207], v25 offset:12800
    ds_read_b64_tr_b16 v[208:209], v26 offset:12288
    v_cvt_pk_bf16_f32 v244, v140, v141
    v_cvt_pk_bf16_f32 v245, v142, v143
    v_cvt_pk_bf16_f32 v246, v144, v145
    v_cvt_pk_bf16_f32 v247, v146, v147
    v_mfma_f32_32x32x16_bf16 v[108:123], v[176:179], a[8:11], v[108:123]
    ds_read_b64_tr_b16 v[210:211], v26 offset:12800
    ds_read_b64_tr_b16 v[212:213], v25 offset:14336
    ds_read_b64_tr_b16 v[214:215], v25 offset:14848
    buffer_load_dwordx4 v17, s[12:15], s75 offen offset:1024 lds
    s_add_u32 s67, s67, 1
    s_cmp_eq_u32 s67, 7
    s_cselect_b32 s67, 0, s67
    v_pk_max_i16 v244, v244, 0
    v_pk_max_i16 v245, v245, 0
    v_pk_max_i16 v246, v246, 0
    v_pk_max_i16 v247, v247, 0
    v_mfma_f32_32x32x16_bf16 v[92:107], v[180:183], a[12:15], v[92:107]
    ds_read_b64_tr_b16 v[216:217], v26 offset:14336
    ds_read_b64_tr_b16 v[218:219], v26 offset:14848
    v_cvt_pk_bf16_f32 v248, v148, v149
    v_cvt_pk_bf16_f32 v249, v150, v151
    v_cvt_pk_bf16_f32 v250, v152, v153
    v_cvt_pk_bf16_f32 v251, v154, v155
    v_mfma_f32_32x32x16_bf16 v[108:123], v[184:187], a[12:15], v[108:123]
    v_pk_max_i16 v248, v248, 0
    v_pk_max_i16 v249, v249, 0
    v_pk_max_i16 v250, v250, 0
    v_pk_max_i16 v251, v251, 0
    s_waitcnt lgkmcnt(8)
    v_mfma_f32_32x32x16_bf16 v[92:107], v[188:191], a[16:19], v[92:107]
    v_mfma_f32_32x32x16_bf16 v[108:123], v[192:195], a[16:19], v[108:123]
    s_waitcnt vmcnt(15) lgkmcnt(0)
    s_barrier
    ds_read_b64_tr_b16 v[156:157], v25 offset:16384
    ds_read_b64_tr_b16 v[158:159], v25 offset:16896
    ds_read_b64_tr_b16 v[160:161], v26 offset:16384
    ds_read_b64_tr_b16 v[162:163], v26 offset:16896
    s_mul_i32 s63, s60, 114688
    s_lshl_b32 s64, s77, 12
    s_add_u32 s63, s63, s64
    s_add_u32 s63, s63, 7340032
    buffer_store_dwordx4 v[236:239], v32, s[28:31], s63 offen offset:0 sc1
    v_mfma_f32_32x32x16_bf16 v[92:107], v[196:199], a[20:23], v[92:107]
    ds_read_b64_tr_b16 v[164:165], v25 offset:18432
    ds_read_b64_tr_b16 v[166:167], v25 offset:18944
    ds_read_b64_tr_b16 v[168:169], v26 offset:18432
    v_mfma_f32_32x32x16_bf16 v[108:123], v[200:203], a[20:23], v[108:123]
    ds_read_b64_tr_b16 v[170:171], v26 offset:18944
    buffer_store_dwordx4 v[240:243], v32, s[28:31], s63 offen offset:1024 sc1
    s_mov_b32 s65, 393216
    s_cmp_eq_u64 s[48:49], 0
    s_cselect_b64 exec, 1, s[48:49]
    buffer_load_dword v58, v55, s[28:31], s65 offen sc1
    s_mov_b64 exec, -1
    v_mfma_f32_32x32x16_bf16 v[92:107], v[204:207], a[24:27], v[92:107]
    ds_read_b64_tr_b16 v[172:173], v25 offset:20480
    ds_read_b64_tr_b16 v[174:175], v25 offset:20992
    ds_read_b64_tr_b16 v[176:177], v26 offset:20480
    v_mfma_f32_32x32x16_bf16 v[108:123], v[208:211], a[24:27], v[108:123]
    ds_read_b64_tr_b16 v[178:179], v26 offset:20992
    ds_read_b64_tr_b16 v[180:181], v25 offset:22528
    ds_read_b64_tr_b16 v[182:183], v25 offset:23040
    buffer_store_dwordx4 v[244:247], v32, s[28:31], s63 offen offset:2048 sc1
    v_mfma_f32_32x32x16_bf16 v[92:107], v[212:215], a[28:31], v[92:107]
    ds_read_b64_tr_b16 v[184:185], v26 offset:22528
    ds_read_b64_tr_b16 v[186:187], v26 offset:23040
    v_mfma_f32_32x32x16_bf16 v[108:123], v[216:219], a[28:31], v[108:123]
    buffer_store_dwordx4 v[248:251], v32, s[28:31], s63 offen offset:3072 sc1
    s_waitcnt lgkmcnt(8)
    v_mfma_f32_32x32x16_bf16 v[92:107], v[156:159], a[32:35], v[92:107]
    ds_read_b64_tr_b16 v[188:189], v25 offset:24576
    ds_read_b64_tr_b16 v[190:191], v25 offset:25088
    ds_read_b64_tr_b16 v[192:193], v26 offset:24576
    v_mfma_f32_32x32x16_bf16 v[108:123], v[160:163], a[32:35], v[108:123]
    ds_read_b64_tr_b16 v[194:195], v26 offset:25088
    ds_read_b64_tr_b16 v[196:197], v25 offset:26624
    ds_read_b64_tr_b16 v[198:199], v25 offset:27136
    v_mfma_f32_32x32x16_bf16 v[92:107], v[164:167], a[36:39], v[92:107]
    ds_read_b64_tr_b16 v[200:201], v26 offset:26624
    ds_read_b64_tr_b16 v[202:203], v26 offset:27136
    v_mfma_f32_32x32x16_bf16 v[108:123], v[168:171], a[36:39], v[108:123]
    s_waitcnt lgkmcnt(8)
    v_mfma_f32_32x32x16_bf16 v[92:107], v[172:175], a[40:43], v[92:107]
    ds_read_b64_tr_b16 v[204:205], v25 offset:28672
    ds_read_b64_tr_b16 v[206:207], v25 offset:29184
    ds_read_b64_tr_b16 v[208:209], v26 offset:28672
    v_mfma_f32_32x32x16_bf16 v[108:123], v[176:179], a[40:43], v[108:123]
    ds_read_b64_tr_b16 v[210:211], v26 offset:29184
    ds_read_b64_tr_b16 v[212:213], v25 offset:30720
    ds_read_b64_tr_b16 v[214:215], v25 offset:31232
    v_mfma_f32_32x32x16_bf16 v[92:107], v[180:183], a[44:47], v[92:107]
    ds_read_b64_tr_b16 v[216:217], v26 offset:30720
    ds_read_b64_tr_b16 v[218:219], v26 offset:31232
    v_mfma_f32_32x32x16_bf16 v[108:123], v[184:187], a[44:47], v[108:123]
    s_waitcnt lgkmcnt(8)
    v_mfma_f32_32x32x16_bf16 v[92:107], v[188:191], a[48:51], v[92:107]
    v_mfma_f32_32x32x16_bf16 v[108:123], v[192:195], a[48:51], v[108:123]
    s_waitcnt vmcnt(7) lgkmcnt(0)
    s_barrier
    ds_read_b64_tr_b16 v[156:157], v25 offset:32768
    ds_read_b64_tr_b16 v[158:159], v25 offset:33280
    ds_read_b64_tr_b16 v[160:161], v26 offset:32768
    ds_read_b64_tr_b16 v[162:163], v26 offset:33280
    v_mfma_f32_32x32x16_bf16 v[92:107], v[196:199], a[52:55], v[92:107]
    ds_read_b64_tr_b16 v[164:165], v25 offset:34816
    ds_read_b64_tr_b16 v[166:167], v25 offset:35328
    ds_read_b64_tr_b16 v[168:169], v26 offset:34816
    v_mfma_f32_32x32x16_bf16 v[108:123], v[200:203], a[52:55], v[108:123]
    ds_read_b64_tr_b16 v[170:171], v26 offset:35328
    s_waitcnt vmcnt(2)
    v_cmp_ne_u32 vcc, v58, v20
    s_nop 1
    s_and_b64 s[86:87], vcc, s[48:49]
    s_cbranch_scc0 L_pollok_2
    s_mov_b32 s65, 0
    s_mov_b32 s61, 393216
L_poll_1:
    s_mov_b64 exec, s[86:87]
    buffer_load_dword v58, v55, s[28:31], s61 offen sc1
    s_mov_b64 exec, -1
    s_waitcnt vmcnt(0)
    v_cmp_ne_u32 vcc, v58, v20
    s_add_u32 s65, s65, 1
    s_nop 0
    s_and_b64 s[86:87], vcc, s[48:49]
    s_cbranch_scc0 L_pollok_2
    s_cmp_lt_u32 s65, 20000
    s_cbranch_scc1 L_poll_1
L_pollok_2:
    v_mfma_f32_32x32x16_bf16 v[92:107], v[204:207], a[56:59], v[92:107]
    ds_read_b64_tr_b16 v[172:173], v25 offset:36864
    ds_read_b64_tr_b16 v[174:175], v25 offset:37376
    ds_read_b64_tr_b16 v[176:177], v26 offset:36864
    s_mul_i32 s47, s84, 448
    s_add_u32 s47, s47, 1048576
    s_mul_i32 s85, s83, 86016
    s_add_u32 s85, s85, s47
    s_add_u32 m0, s45, 8192
    s_nop 0
    buffer_load_dwordx4 v44, s[28:31], s85 offen offset:0 sc1 lds
    v_mfma_f32_32x32x16_bf16 v[108:123], v[208:211], a[56:59], v[108:123]
    ds_read_b64_tr_b16 v[178:179], v26 offset:37376
    ds_read_b64_tr_b16 v[180:181], v25 offset:38912
    ds_read_b64_tr_b16 v[182:183], v25 offset:39424
    buffer_load_dwordx4 v45, s[28:31], s85 offen offset:1024 sc1 lds
    v_mfma_f32_32x32x16_bf16 v[92:107], v[212:215], a[60:63], v[92:107]
    ds_read_b64_tr_b16 v[184:185], v26 offset:38912
    ds_read_b64_tr_b16 v[186:187], v26 offset:39424
    s_mul_i32 s85, s3, 6144
    s_add_u32 m0, s85, 65536
    s_add_i32 s85, s81, 0
    s_max_i32 s85, s85, 0
    s_mul_i32 s85, s85, 86016
    s_add_u32 s85, s85, s47
    s_add_u32 s85, s85, 7168
    buffer_load_dwordx4 v44, s[28:31], s85 offen offset:0 sc1 lds
    v_mfma_f32_32x32x16_bf16 v[108:123], v[216:219], a[60:63], v[108:123]
    buffer_load_dwordx4 v45, s[28:31], s85 offen offset:1024 sc1 lds
    s_waitcnt lgkmcnt(8)
    v_mfma_f32_32x32x16_bf16 v[92:107], v[156:159], a[64:67], v[92:107]
    ds_read_b64_tr_b16 v[188:189], v25 offset:40960
    ds_read_b64_tr_b16 v[190:191], v25 offset:41472
    ds_read_b64_tr_b16 v[192:193], v26 offset:40960
    v_mfma_f32_32x32x16_bf16 v[108:123], v[160:163], a[64:67], v[108:123]
    ds_read_b64_tr_b16 v[194:195], v26 offset:41472
    ds_read_b64_tr_b16 v[196:197], v25 offset:43008
    ds_read_b64_tr_b16 v[198:199], v25 offset:43520
    s_mul_i32 s85, s3, 6144
    s_add_u32 m0, s85, 67584
    s_add_i32 s85, s81, 1
    s_max_i32 s85, s85, 0
    s_mul_i32 s85, s85, 86016
    s_add_u32 s85, s85, s47
    s_add_u32 s85, s85, 7168
    buffer_load_dwordx4 v44, s[28:31], s85 offen offset:0 sc1 lds
    v_mfma_f32_32x32x16_bf16 v[92:107], v[164:167], a[68:71], v[92:107]
    ds_read_b64_tr_b16 v[200:201], v26 offset:43008
    ds_read_b64_tr_b16 v[202:203], v26 offset:43520
    v_mfma_f32_32x32x16_bf16 v[108:123], v[168:171], a[68:71], v[108:123]
    buffer_load_dwordx4 v45, s[28:31], s85 offen offset:1024 sc1 lds
    s_waitcnt lgkmcnt(8)
    v_mfma_f32_32x32x16_bf16 v[92:107], v[172:175], a[72:75], v[92:107]
    ds_read_b64_tr_b16 v[204:205], v25 offset:45056
    ds_read_b64_tr_b16 v[206:207], v25 offset:45568
    ds_read_b64_tr_b16 v[208:209], v26 offset:45056
    v_mfma_f32_32x32x16_bf16 v[108:123], v[176:179], a[72:75], v[108:123]
    ds_read_b64_tr_b16 v[210:211], v26 offset:45568
    ds_read_b64_tr_b16 v[212:213], v25 offset:47104
    ds_read_b64_tr_b16 v[214:215], v25 offset:47616
    s_mul_i32 s85, s3, 6144
    s_add_u32 m0, s85, 69632
    s_add_i32 s85, s81, 2
    s_max_i32 s85, s85, 0
    s_mul_i32 s85, s85, 86016
    s_add_u32 s85, s85, s47
    s_add_u32 s85, s85, 7168
    buffer_load_dwordx4 v44, s[28:31], s85 offen offset:0 sc1 lds
    v_mfma_f32_32x32x16_bf16 v[92:107], v[180:183], a[76:79], v[92:107]
    ds_read_b64_tr_b16 v[216:217], v26 offset:47104
    ds_read_b64_tr_b16 v[218:219], v26 offset:47616
    v_mfma_f32_32x32x16_bf16 v[108:123], v[184:187], a[76:79], v[108:123]
    buffer_load_dwordx4 v45, s[28:31], s85 offen offset:1024 sc1 lds
    s_waitcnt lgkmcnt(8)
    v_mfma_f32_32x32x16_bf16 v[92:107], v[188:191], a[80:83], v[92:107]
    v_mfma_f32_32x32x16_bf16 v[108:123], v[192:195], a[80:83], v[108:123]
    s_waitcnt lgkmcnt(0)
    s_barrier
    ds_read_b64_tr_b16 v[156:157], v25 offset:49152
    ds_read_b64_tr_b16 v[158:159], v25 offset:49664
    ds_read_b64_tr_b16 v[160:161], v26 offset:49152
    ds_read_b64_tr_b16 v[162:163], v26 offset:49664
    s_add_u32 m0, s44, 0
    s_nop 0
    buffer_load_dwordx4 v37, s[20:23], s36 offen offset:0 lds
    v_mfma_f32_32x32x16_bf16 v[92:107], v[196:199], a[84:87], v[92:107]
    ds_read_b64_tr_b16 v[164:165], v25 offset:51200
    ds_read_b64_tr_b16 v[166:167], v25 offset:51712
    ds_read_b64_tr_b16 v[168:169], v26 offset:51200
    v_mfma_f32_32x32x16_bf16 v[108:123], v[200:203], a[84:87], v[108:123]
    ds_read_b64_tr_b16 v[170:171], v26 offset:51712
    buffer_load_dwordx4 v38, s[20:23], s36 offen offset:1024 lds
    v_mfma_f32_32x32x16_bf16 v[92:107], v[204:207], a[88:91], v[92:107]
    ds_read_b64_tr_b16 v[172:173], v25 offset:53248
    ds_read_b64_tr_b16 v[174:175], v25 offset:53760
    ds_read_b64_tr_b16 v[176:177], v26 offset:53248
    v_mfma_f32_32x32x16_bf16 v[108:123], v[208:211], a[88:91], v[108:123]
    ds_read_b64_tr_b16 v[178:179], v26 offset:53760
    ds_read_b64_tr_b16 v[180:181], v25 offset:55296
    ds_read_b64_tr_b16 v[182:183], v25 offset:55808
    buffer_load_dwordx4 v39, s[20:23], s36 offen offset:2048 lds
    v_mfma_f32_32x32x16_bf16 v[92:107], v[212:215], a[92:95], v[92:107]
    ds_read_b64_tr_b16 v[184:185], v26 offset:55296
    ds_read_b64_tr_b16 v[186:187], v26 offset:55808
    v_mfma_f32_32x32x16_bf16 v[108:123], v[216:219], a[92:95], v[108:123]
    buffer_load_dwordx4 v40, s[20:23], s36 offen offset:3072 lds
    s_add_u32 s36, s36, 28672
    s_cmp_eq_u32 s36, s38
    s_cselect_b32 s36, s37, s36
    s_waitcnt vmcnt(12)
    s_mov_b32 s61, 393216
    s_mov_b64 exec, 2
    buffer_store_dword v20, v29, s[28:31], s61 offen sc1
    s_mov_b64 exec, -1
    s_waitcnt lgkmcnt(8)
    v_mfma_f32_32x32x16_bf16 v[92:107], v[156:159], a[96:99], v[92:107]
    v_mfma_f32_32x32x16_bf16 v[108:123], v[160:163], a[96:99], v[108:123]
    v_mfma_f32_32x32x16_bf16 v[92:107], v[164:167], a[100:103], v[92:107]
    v_mfma_f32_32x32x16_bf16 v[108:123], v[168:171], a[100:103], v[108:123]
    s_waitcnt lgkmcnt(0)
    v_mfma_f32_32x32x16_bf16 v[92:107], v[172:175], a[104:107], v[92:107]
    v_mfma_f32_32x32x16_bf16 v[108:123], v[176:179], a[104:107], v[108:123]
    v_mfma_f32_32x32x16_bf16 v[92:107], v[180:183], a[108:111], v[92:107]
    v_mfma_f32_32x32x16_bf16 v[108:123], v[184:187], a[108:111], v[108:123]
    s_nop 10
    v_cvt_pk_bf16_f32 v220, v92, v93
    v_cvt_pk_bf16_f32 v221, v94, v95
    v_cvt_pk_bf16_f32 v222, v96, v97
    v_cvt_pk_bf16_f32 v223, v98, v99
    v_pk_max_i16 v220, v220, 0
    v_pk_max_i16 v221, v221, 0
    v_pk_max_i16 v222, v222, 0
    v_pk_max_i16 v223, v223, 0
    v_cvt_pk_bf16_f32 v224, v100, v101
    v_cvt_pk_bf16_f32 v225, v102, v103
    v_cvt_pk_bf16_f32 v226, v104, v105
    v_cvt_pk_bf16_f32 v227, v106, v107
    v_pk_max_i16 v224, v224, 0
    v_pk_max_i16 v225, v225, 0
    v_pk_max_i16 v226, v226, 0
    v_pk_max_i16 v227, v227, 0
    v_cvt_pk_bf16_f32 v228, v108, v109
    v_cvt_pk_bf16_f32 v229, v110, v111
    v_cvt_pk_bf16_f32 v230, v112, v113
    v_cvt_pk_bf16_f32 v231, v114, v115
    v_pk_max_i16 v228, v228, 0
    v_pk_max_i16 v229, v229, 0
    v_pk_max_i16 v230, v230, 0
    v_pk_max_i16 v231, v231, 0
    v_cvt_pk_bf16_f32 v232, v116, v117
    v_cvt_pk_bf16_f32 v233, v118, v119
    v_cvt_pk_bf16_f32 v234, v120, v121
    v_cvt_pk_bf16_f32 v235, v122, v123
    v_pk_max_i16 v232, v232, 0
    v_pk_max_i16 v233, v233, 0
    v_pk_max_i16 v234, v234, 0
    v_pk_max_i16 v235, v235, 0
    s_mov_b32 s65, 393216
    s_cmp_eq_u64 s[50:51], 0
    s_cselect_b64 exec, 1, s[50:51]
    buffer_load_dword v58, v55, s[28:31], s65 offen sc1
    s_mov_b64 exec, -1
    s_mul_i32 s63, s60, 114688
    s_lshl_b32 s64, s78, 12
    s_add_u32 s63, s63, s64
    s_add_u32 s63, s63, 7340032
    buffer_store_dwordx4 v[220:223], v32, s[28:31], s63 offen offset:0 sc1
    buffer_store_dwordx4 v[224:227], v32, s[28:31], s63 offen offset:1024 sc1
    buffer_store_dwordx4 v[228:231], v32, s[28:31], s63 offen offset:2048 sc1
    buffer_store_dwordx4 v[232:235], v32, s[28:31], s63 offen offset:3072 sc1
    v_mov_b32 v252, 0x3f803f80
    v_mov_b32 v253, 0x3f803f80
    v_mov_b32 v254, 0x3f803f80
    v_mov_b32 v255, 0x3f803f80
    s_waitcnt vmcnt(10)
    s_branch L_p2
L_heavy:
    s_waitcnt lgkmcnt(8)
    v_mfma_f32_32x32x16_bf16 v[124:139], v[188:191], a[0:3], 0
    ds_read_b64_tr_b16 v[156:157], v25 offset:8192
    ds_read_b64_tr_b16 v[158:159], v25 offset:8704
    ds_read_b64_tr_b16 v[160:161], v26 offset:8192
    s_mul_i32 s63, s60, 86016
    s_lshl_b32 s64, s57, 10
    s_add_u32 s63, s63, s64
    s_add_u32 s63, s63, 1048576
    s_add_u32 s64, s63, 43008
    v_cvt_pk_bf16_f32 v220, v60, v61
    v_cvt_pk_bf16_f32 v221, v62, v63
    v_cvt_pk_bf16_f32 v222, v64, v65
    v_mfma_f32_32x32x16_bf16 v[140:155], v[192:195], a[0:3], 0
    ds_read_b64_tr_b16 v[162:163], v26 offset:8704
    ds_read_b64_tr_b16 v[164:165], v25 offset:10240
    ds_read_b64_tr_b16 v[166:167], v25 offset:10752
    v_cvt_pk_bf16_f32 v223, v66, v67
    buffer_store_dwordx4 v[220:223], v28, s[28:31], s63 offen offset:0 sc1
    v_cvt_pk_bf16_f32 v224, v68, v69
    v_cvt_pk_bf16_f32 v225, v70, v71
    v_mfma_f32_32x32x16_bf16 v[124:139], v[196:199], a[4:7], v[124:139]
    ds_read_b64_tr_b16 v[168:169], v26 offset:10240
    ds_read_b64_tr_b16 v[170:171], v26 offset:10752
    v_cvt_pk_bf16_f32 v226, v72, v73
    v_cvt_pk_bf16_f32 v227, v74, v75
    buffer_store_dwordx4 v[224:227], v28, s[28:31], s64 offen offset:0 sc1
    v_cvt_pk_bf16_f32 v228, v76, v77
    v_mfma_f32_32x32x16_bf16 v[140:155], v[200:203], a[4:7], v[140:155]
    v_cvt_pk_bf16_f32 v229, v78, v79
    v_cvt_pk_bf16_f32 v230, v80, v81
    v_cvt_pk_bf16_f32 v231, v82, v83
    buffer_store_dwordx4 v[228:231], v28, s[28:31], s63 offen offset:512 sc1
    s_waitcnt lgkmcnt(8)
    v_mfma_f32_32x32x16_bf16 v[124:139], v[204:207], a[8:11], v[124:139]
    ds_read_b64_tr_b16 v[172:173], v25 offset:12288
    ds_read_b64_tr_b16 v[174:175], v25 offset:12800
    ds_read_b64_tr_b16 v[176:177], v26 offset:12288
    v_cvt_pk_bf16_f32 v232, v84, v85
    v_cvt_pk_bf16_f32 v233, v86, v87
    v_cvt_pk_bf16_f32 v234, v88, v89
    v_cvt_pk_bf16_f32 v235, v90, v91
    v_mfma_f32_32x32x16_bf16 v[140:155], v[208:211], a[8:11], v[140:155]
    ds_read_b64_tr_b16 v[178:179], v26 offset:12800
    ds_read_b64_tr_b16 v[180:181], v25 offset:14336
    ds_read_b64_tr_b16 v[182:183], v25 offset:14848
    buffer_store_dwordx4 v[232:235], v28, s[28:31], s64 offen offset:512 sc1
    v_mfma_f32_32x32x16_bf16 v[124:139], v[212:215], a[12:15], v[124:139]
    ds_read_b64_tr_b16 v[184:185], v26 offset:14336
    ds_read_b64_tr_b16 v[186:187], v26 offset:14848
    v_mfma_f32_32x32x16_bf16 v[140:155], v[216:219], a[12:15], v[140:155]
    s_waitcnt lgkmcnt(8)
    v_mfma_f32_32x32x16_bf16 v[124:139], v[156:159], a[16:19], v[124:139]
    v_mfma_f32_32x32x16_bf16 v[140:155], v[160:163], a[16:19], v[140:155]
    s_waitcnt vmcnt(10) lgkmcnt(0)
    s_barrier
    ds_read_b64_tr_b16 v[188:189], v25 offset:16384
    ds_read_b64_tr_b16 v[190:191], v25 offset:16896
    ds_read_b64_tr_b16 v[192:193], v26 offset:16384
    ds_read_b64_tr_b16 v[194:195], v26 offset:16896
    s_mul_i32 s71, s3, 57344
    s_add_u32 s71, s71, 3456
    s_add_u32 m0, s73, 0
    s_mul_i32 s75, s67, 229376
    s_add_u32 s75, s75, s71
    buffer_load_dwordx4 v16, s[12:15], s75 offen lds
    v_mfma_f32_32x32x16_bf16 v[124:139], v[164:167], a[20:23], v[124:139]
    ds_read_b64_tr_b16 v[196:197], v25 offset:18432
    ds_read_b64_tr_b16 v[198:199], v25 offset:18944
    ds_read_b64_tr_b16 v[200:201], v26 offset:18432
    v_mfma_f32_32x32x16_bf16 v[140:155], v[168:171], a[20:23], v[140:155]
    ds_read_b64_tr_b16 v[202:203], v26 offset:18944
    buffer_load_dwordx4 v17, s[12:15], s75 offen offset:1024 lds
    s_add_u32 s67, s67, 1
    s_cmp_eq_u32 s67, 7
    s_cselect_b32 s67, 0, s67
    v_mfma_f32_32x32x16_bf16 v[124:139], v[172:175], a[24:27], v[124:139]
    ds_read_b64_tr_b16 v[204:205], v25 offset:20480
    ds_read_b64_tr_b16 v[206:207], v25 offset:20992
    ds_read_b64_tr_b16 v[208:209], v26 offset:20480
    v_mfma_f32_32x32x16_bf16 v[140:155], v[176:179], a[24:27], v[140:155]
    ds_read_b64_tr_b16 v[210:211], v26 offset:20992
    ds_read_b64_tr_b16 v[212:213], v25 offset:22528
    ds_read_b64_tr_b16 v[214:215], v25 offset:23040
    s_add_u32 m0, s73, 8192
    s_mul_i32 s75, s67, 229376
    s_add_u32 s75, s75, s71
    buffer_load_dwordx4 v16, s[12:15], s75 offen lds
    v_mfma_f32_32x32x16_bf16 v[124:139], v[180:183], a[28:31], v[124:139]
    ds_read_b64_tr_b16 v[216:217], v26 offset:22528
    ds_read_b64_tr_b16 v[218:219], v26 offset:23040
    v_mfma_f32_32x32x16_bf16 v[140:155], v[184:187], a[28:31], v[140:155]
    buffer_load_dwordx4 v17, s[12:15], s75 offen offset:1024 lds
    s_add_u32 s67, s67, 1
    s_cmp_eq_u32 s67, 7
    s_cselect_b32 s67, 0, s67
    s_waitcnt lgkmcnt(8)
    v_mfma_f32_32x32x16_bf16 v[124:139], v[188:191], a[32:35], v[124:139]
    ds_read_b64_tr_b16 v[156:157], v25 offset:24576
    ds_read_b64_tr_b16 v[158:159], v25 offset:25088
    ds_read_b64_tr_b16 v[160:161], v26 offset:24576
    v_mfma_f32_32x32x16_bf16 v[140:155], v[192:195], a[32:35], v[140:155]
    ds_read_b64_tr_b16 v[162:163], v26 offset:25088
    ds_read_b64_tr_b16 v[164:165], v25 offset:26624
    ds_read_b64_tr_b16 v[166:167], v25 offset:27136
    v_mfma_f32_32x32x16_bf16 v[124:139], v[196:199], a[36:39], v[124:139]
    ds_read_b64_tr_b16 v[168:169], v26 offset:26624
    ds_read_b64_tr_b16 v[170:171], v26 offset:27136
    v_mfma_f32_32x32x16_bf16 v[140:155], v[200:203], a[36:39], v[140:155]
    s_waitcnt lgkmcnt(8)
    v_mfma_f32_32x32x16_bf16 v[124:139], v[204:207], a[40:43], v[124:139]
    ds_read_b64_tr_b16 v[172:173], v25 offset:28672
    ds_read_b64_tr_b16 v[174:175], v25 offset:29184
    ds_read_b64_tr_b16 v[176:177], v26 offset:28672
    v_mfma_f32_32x32x16_bf16 v[140:155], v[208:211], a[40:43], v[140:155]
    ds_read_b64_tr_b16 v[178:179], v26 offset:29184
    ds_read_b64_tr_b16 v[180:181], v25 offset:30720
    ds_read_b64_tr_b16 v[182:183], v25 offset:31232
    v_mfma_f32_32x32x16_bf16 v[124:139], v[212:215], a[44:47], v[124:139]
    ds_read_b64_tr_b16 v[184:185], v26 offset:30720
    ds_read_b64_tr_b16 v[186:187], v26 offset:31232
    v_mfma_f32_32x32x16_bf16 v[140:155], v[216:219], a[44:47], v[140:155]
    s_waitcnt lgkmcnt(8)
    v_mfma_f32_32x32x16_bf16 v[124:139], v[156:159], a[48:51], v[124:139]
    v_mfma_f32_32x32x16_bf16 v[140:155], v[160:163], a[48:51], v[140:155]
    s_waitcnt vmcnt(10) lgkmcnt(0)
    s_barrier
    ds_read_b64_tr_b16 v[188:189], v25 offset:32768
    ds_read_b64_tr_b16 v[190:191], v25 offset:33280
    ds_read_b64_tr_b16 v[192:193], v26 offset:32768
    ds_read_b64_tr_b16 v[194:195], v26 offset:33280
    s_add_u32 m0, s73, 16384
    s_mul_i32 s75, s67, 229376
    s_add_u32 s75, s75, s71
    buffer_load_dwordx4 v16, s[12:15], s75 offen lds
    v_mfma_f32_32x32x16_bf16 v[124:139], v[164:167], a[52:55], v[124:139]
    ds_read_b64_tr_b16 v[196:197], v25 offset:34816
    ds_read_b64_tr_b16 v[198:199], v25 offset:35328
    ds_read_b64_tr_b16 v[200:201], v26 offset:34816
    v_mfma_f32_32x32x16_bf16 v[140:155], v[168:171], a[52:55], v[140:155]
    ds_read_b64_tr_b16 v[202:203], v26 offset:35328
    buffer_load_dwordx4 v17, s[12:15], s75 offen offset:1024 lds
    s_add_u32 s67, s67, 1
    s_cmp_eq_u32 s67, 7
    s_cselect_b32 s67, 0, s67
    v_mfma_f32_32x32x16_bf16 v[124:139], v[172:175], a[56:59], v[124:139]
    ds_read_b64_tr_b16 v[204:205], v25 offset:36864
    ds_read_b64_tr_b16 v[206:207], v25 offset:37376
    ds_read_b64_tr_b16 v[208:209], v26 offset:36864
    v_mfma_f32_32x32x16_bf16 v[140:155], v[176:179], a[56:59], v[140:155]
    ds_read_b64_tr_b16 v[210:211], v26 offset:37376
    ds_read_b64_tr_b16 v[212:213], v25 offset:38912
    ds_read_b64_tr_b16 v[214:215], v25 offset:39424
    s_add_u32 m0, s73, 24576
    s_mul_i32 s75, s67, 229376
    s_add_u32 s75, s75, s71
    buffer_load_dwordx4 v16, s[12:15], s75 offen lds
    v_mfma_f32_32x32x16_bf16 v[124:139], v[180:183], a[60:63], v[124:139]
    ds_read_b64_tr_b16 v[216:217], v26 offset:38912
    ds_read_b64_tr_b16 v[218:219], v26 offset:39424
    v_mfma_f32_32x32x16_bf16 v[140:155], v[184:187], a[60:63], v[140:155]
    buffer_load_dwordx4 v17, s[12:15], s75 offen offset:1024 lds
    s_add_u32 s67, s67, 1
    s_cmp_eq_u32 s67, 7
    s_cselect_b32 s67, 0, s67
    s_waitcnt lgkmcnt(8)
    v_mfma_f32_32x32x16_bf16 v[124:139], v[188:191], a[64:67], v[124:139]
    ds_read_b64_tr_b16 v[156:157], v25 offset:40960
    ds_read_b64_tr_b16 v[158:159], v25 offset:41472
    ds_read_b64_tr_b16 v[160:161], v26 offset:40960
    v_mfma_f32_32x32x16_bf16 v[140:155], v[192:195], a[64:67], v[140:155]
    ds_read_b64_tr_b16 v[162:163], v26 offset:41472
    ds_read_b64_tr_b16 v[164:165], v25 offset:43008
    ds_read_b64_tr_b16 v[166:167], v25 offset:43520
    v_mfma_f32_32x32x16_bf16 v[124:139], v[196:199], a[68:71], v[124:139]
    ds_read_b64_tr_b16 v[168:169], v26 offset:43008
    ds_read_b64_tr_b16 v[170:171], v26 offset:43520
    v_mfma_f32_32x32x16_bf16 v[140:155], v[200:203], a[68:71], v[140:155]
    s_waitcnt lgkmcnt(8)
    v_mfma_f32_32x32x16_bf16 v[124:139], v[204:207], a[72:75], v[124:139]
    ds_read_b64_tr_b16 v[172:173], v25 offset:45056
    ds_read_b64_tr_b16 v[174:175], v25 offset:45568
    ds_read_b64_tr_b16 v[176:177], v26 offset:45056
    v_mfma_f32_32x32x16_bf16 v[140:155], v[208:211], a[72:75], v[140:155]
    ds_read_b64_tr_b16 v[178:179], v26 offset:45568
    ds_read_b64_tr_b16 v[180:181], v25 offset:47104
    ds_read_b64_tr_b16 v[182:183], v25 offset:47616
    v_mfma_f32_32x32x16_bf16 v[124:139], v[212:215], a[76:79], v[124:139]
    ds_read_b64_tr_b16 v[184:185], v26 offset:47104
    ds_read_b64_tr_b16 v[186:187], v26 offset:47616
    v_mfma_f32_32x32x16_bf16 v[140:155], v[216:219], a[76:79], v[140:155]
    s_waitcnt lgkmcnt(8)
    v_mfma_f32_32x32x16_bf16 v[124:139], v[156:159], a[80:83], v[124:139]
    v_mfma_f32_32x32x16_bf16 v[140:155], v[160:163], a[80:83], v[140:155]
    s_waitcnt vmcnt(12) lgkmcnt(0)
    s_barrier
    ds_read_b64_tr_b16 v[188:189], v25 offset:49152
    ds_read_b64_tr_b16 v[190:191], v25 offset:49664
    ds_read_b64_tr_b16 v[192:193], v26 offset:49152
    ds_read_b64_tr_b16 v[194:195], v26 offset:49664
    s_add_u32 m0, s73, 32768
    s_mul_i32 s75, s67, 229376
    s_add_u32 s75, s75, s71
    buffer_load_dwordx4 v16, s[12:15], s75 offen lds
    v_mfma_f32_32x32x16_bf16 v[124:139], v[164:167], a[84:87], v[124:139]
    ds_read_b64_tr_b16 v[196:197], v25 offset:51200
    ds_read_b64_tr_b16 v[198:199], v25 offset:51712
    ds_read_b64_tr_b16 v[200:201], v26 offset:51200
    v_mfma_f32_32x32x16_bf16 v[140:155], v[168:171], a[84:87], v[140:155]
    ds_read_b64_tr_b16 v[202:203], v26 offset:51712
    buffer_load_dwordx4 v17, s[12:15], s75 offen offset:1024 lds
    s_add_u32 s67, s67, 1
    s_cmp_eq_u32 s67, 7
    s_cselect_b32 s67, 0, s67
    s_waitcnt vmcnt(10)
    s_mov_b32 s61, 393216
    s_mov_b64 exec, 1
    buffer_store_dword v20, v29, s[28:31], s61 offen sc1
    s_mov_b64 exec, -1
    s_add_u32 m0, s73, 40960
    s_mul_i32 s75, s67, 229376
    s_add_u32 s75, s75, s71
    buffer_load_dwordx4 v16, s[12:15], s75 offen lds
    buffer_load_dwordx4 v17, s[12:15], s75 offen offset:1024 lds
    s_add_u32 s67, s67, 1
    s_cmp_eq_u32 s67, 7
    s_cselect_b32 s67, 0, s67
    s_mov_b32 s4, s88
    s_and_b32 s5, s89, 0xffff
    s_mov_b32 s6, 896
    s_mov_b32 s7, 0x00020000
    s_mov_b32 s74, s45
    s_mov_b32 exec_hi, 0x00ffffff
    s_mov_b32 m0, s74
    s_nop 0
    buffer_load_dwordx4 v32, s[4:7], 0 offen lds
    s_add_u32 m0, s74, 896
    s_nop 0
    buffer_load_dwordx4 v32, s[4:7], 0 offen lds
    s_mov_b64 exec, -1
    s_lshl_b32 s66, s79, 7
    s_add_u32 s66, s66, s74
    v_lshl_add_u32 v10, v7, 4, s66
    v_mfma_f32_32x32x16_bf16 v[124:139], v[172:175], a[88:91], v[124:139]
    ds_read_b64_tr_b16 v[204:205], v25 offset:53248
    ds_read_b64_tr_b16 v[206:207], v25 offset:53760
    ds_read_b64_tr_b16 v[208:209], v26 offset:53248
    v_mfma_f32_32x32x16_bf16 v[140:155], v[176:179], a[88:91], v[140:155]
    ds_read_b64_tr_b16 v[210:211], v26 offset:53760
    ds_read_b64_tr_b16 v[212:213], v25 offset:55296
    ds_read_b64_tr_b16 v[214:215], v25 offset:55808
    v_mfma_f32_32x32x16_bf16 v[124:139], v[180:183], a[92:95], v[124:139]
    ds_read_b64_tr_b16 v[216:217], v26 offset:55296
    ds_read_b64_tr_b16 v[218:219], v26 offset:55808
    v_mfma_f32_32x32x16_bf16 v[140:155], v[184:187], a[92:95], v[140:155]
    s_waitcnt lgkmcnt(8)
    v_mfma_f32_32x32x16_bf16 v[124:139], v[188:191], a[96:99], v[124:139]
    v_mfma_f32_32x32x16_bf16 v[140:155], v[192:195], a[96:99], v[140:155]
    s_waitcnt vmcnt(11) lgkmcnt(0)
    s_barrier
    ds_read_b64_tr_b16 v[156:157], v27 offset:0
    ds_read_b64_tr_b16 v[158:159], v27 offset:512
    ds_read_b64_tr_b16 v[160:161], v27 offset:2048
    ds_read_b64_tr_b16 v[162:163], v27 offset:2560
    s_add_u32 m0, s73, 49152
    s_mul_i32 s75, s67, 229376
    s_add_u32 s75, s75, s71
    buffer_load_dwordx4 v16, s[12:15], s75 offen lds
    v_mfma_f32_32x32x16_bf16 v[124:139], v[196:199], a[100:103], v[124:139]
    ds_read_b64_tr_b16 v[164:165], v27 offset:4096
    ds_read_b64_tr_b16 v[166:167], v27 offset:4608
    ds_read_b64_tr_b16 v[168:169], v27 offset:6144
    v_mfma_f32_32x32x16_bf16 v[140:155], v[200:203], a[100:103], v[140:155]
    ds_read_b64_tr_b16 v[170:171], v27 offset:6656
    buffer_load_dwordx4 v17, s[12:15], s75 offen offset:1024 lds
    s_add_u32 s67, s67, 1
    s_cmp_eq_u32 s67, 7
    s_cselect_b32 s67, 0, s67
    v_mfma_f32_32x32x16_bf16 v[124:139], v[204:207], a[104:107], v[124:139]
    ds_read_b64_tr_b16 v[172:173], v27 offset:8192
    ds_read_b64_tr_b16 v[174:175], v27 offset:8704
    ds_read_b64_tr_b16 v[176:177], v27 offset:10240
    v_mfma_f32_32x32x16_bf16 v[140:155], v[208:211], a[104:107], v[140:155]
    ds_read_b64_tr_b16 v[178:179], v27 offset:10752
    ds_read_b64_tr_b16 v[180:181], v27 offset:12288
    ds_read_b64_tr_b16 v[182:183], v27 offset:12800
    v_mfma_f32_32x32x16_bf16 v[124:139], v[212:215], a[108:111], v[124:139]
    ds_read_b64_tr_b16 v[184:185], v27 offset:14336
    ds_read_b64_tr_b16 v[186:187], v27 offset:14848
    v_mfma_f32_32x32x16_bf16 v[140:155], v[216:219], a[108:111], v[140:155]
    s_waitcnt lgkmcnt(8)
    v_mfma_f32_32x32x16_bf16 v[92:107], v[156:159], a[0:3], 0
    s_mul_i32 s63, s60, 114688
    s_lshl_b32 s64, s77, 12
    s_add_u32 s63, s63, s64
    s_add_u32 s63, s63, 7340032
    s_nop 2
    v_cvt_pk_bf16_f32 v236, v124, v125
    v_cvt_pk_bf16_f32 v237, v126, v127
    v_cvt_pk_bf16_f32 v238, v128, v129
    v_mfma_f32_32x32x16_bf16 v[92:107], v[160:163], a[4:7], v[92:107]
    s_waitcnt vmcnt(9) lgkmcnt(0)
    s_barrier
    ds_read_b64_tr_b16 v[188:189], v27 offset:16384
    ds_read_b64_tr_b16 v[190:191], v27 offset:16896
    ds_read_b64_tr_b16 v[192:193], v27 offset:18432
    ds_read_b64_tr_b16 v[194:195], v27 offset:18944
    s_mul_i32 s71, s3, 57344
    s_lshl_b32 s75, s78, 7
    s_add_u32 s71, s71, s75
    s_add_u32 m0, s73, 0
    s_mul_i32 s75, s67, 229376
    s_add_u32 s75, s75, s71
    buffer_load_dwordx4 v16, s[12:15], s75 offen lds
    v_cvt_pk_bf16_f32 v239, v130, v131
    v_pk_max_i16 v236, v236, 0
    v_pk_max_i16 v237, v237, 0
    v_pk_max_i16 v238, v238, 0
    v_mfma_f32_32x32x16_bf16 v[92:107], v[164:167], a[8:11], v[92:107]
    ds_read_b64_tr_b16 v[196:197], v27 offset:20480
    ds_read_b64_tr_b16 v[198:199], v27 offset:20992
    ds_read_b64_tr_b16 v[200:201], v27 offset:22528
    v_pk_max_i16 v239, v239, 0
    buffer_store_dwordx4 v[236:239], v32, s[28:31], s63 offen offset:0 sc1
    v_cvt_pk_bf16_f32 v240, v132, v133
    v_cvt_pk_bf16_f32 v241, v134, v135
    v_mfma_f32_32x32x16_bf16 v[92:107], v[168:171], a[12:15], v[92:107]
    ds_read_b64_tr_b16 v[202:203], v27 offset:23040
    buffer_load_dwordx4 v17, s[12:15], s75 offen offset:1024 lds
    s_add_u32 s67, s67, 1
    s_cmp_eq_u32 s67, 7
    s_cselect_b32 s67, 0, s67
    v_cvt_pk_bf16_f32 v242, v136, v137
    v_cvt_pk_bf16_f32 v243, v138, v139
    v_pk_max_i16 v240, v240, 0
    v_pk_max_i16 v241, v241, 0
    v_mfma_f32_32x32x16_bf16 v[92:107], v[172:175], a[16:19], v[92:107]
    ds_read_b64_tr_b16 v[204:205], v27 offset:24576
    ds_read_b64_tr_b16 v[206:207], v27 offset:25088
    ds_read_b64_tr_b16 v[208:209], v27 offset:26624
    v_pk_max_i16 v242, v242, 0
    v_pk_max_i16 v243, v243, 0
    buffer_store_dwordx4 v[240:243], v32, s[28:31], s63 offen offset:1024 sc1
    v_cvt_pk_bf16_f32 v244, v140, v141
    v_mfma_f32_32x32x16_bf16 v[92:107], v[176:179], a[20:23], v[92:107]
    ds_read_b64_tr_b16 v[210:211], v27 offset:27136
    ds_read_b64_tr_b16 v[212:213], v27 offset:28672
    ds_read_b64_tr_b16 v[214:215], v27 offset:29184
    s_add_u32 m0, s73, 8192
    s_mul_i32 s75, s67, 229376
    s_add_u32 s75, s75, s71
    buffer_load_dwordx4 v16, s[12:15], s75 offen lds
    v_cvt_pk_bf16_f32 v245, v142, v143
    v_cvt_pk_bf16_f32 v246, v144, v145
    v_cvt_pk_bf16_f32 v247, v146, v147
    v_pk_max_i16 v244, v244, 0
    v_mfma_f32_32x32x16_bf16 v[92:107], v[180:183], a[24:27], v[92:107]
    ds_read_b64_tr_b16 v[216:217], v27 offset:30720
    ds_read_b64_tr_b16 v[218:219], v27 offset:31232
    v_pk_max_i16 v245, v245, 0
    v_pk_max_i16 v246, v246, 0
    v_pk_max_i16 v247, v247, 0
    buffer_store_dwordx4 v[244:247], v32, s[28:31], s63 offen offset:2048 sc1
    v_mfma_f32_32x32x16_bf16 v[92:107], v[184:187], a[28:31], v[92:107]
    buffer_load_dwordx4 v17, s[12:15], s75 offen offset:1024 lds
    s_add_u32 s67, s67, 1
    s_cmp_eq_u32 s67, 7
    s_cselect_b32 s67, 0, s67
    v_cvt_pk_bf16_f32 v248, v148, v149
    v_cvt_pk_bf16_f32 v249, v150, v151
    v_cvt_pk_bf16_f32 v250, v152, v153
    v_cvt_pk_bf16_f32 v251, v154, v155
    s_waitcnt lgkmcnt(8)
    v_mfma_f32_32x32x16_bf16 v[92:107], v[188:191], a[32:35], v[92:107]
    v_pk_max_i16 v248, v248, 0
    v_pk_max_i16 v249, v249, 0
    v_pk_max_i16 v250, v250, 0
    v_pk_max_i16 v251, v251, 0
    v_mfma_f32_32x32x16_bf16 v[92:107], v[192:195], a[36:39], v[92:107]
    s_waitcnt vmcnt(11) lgkmcnt(0)
    s_barrier
    ds_read_b64_tr_b16 v[156:157], v27 offset:32768
    ds_read_b64_tr_b16 v[158:159], v27 offset:33280
    ds_read_b64_tr_b16 v[160:161], v27 offset:34816
    ds_read_b64_tr_b16 v[162:163], v27 offset:35328
    s_add_u32 m0, s73, 16384
    s_mul_i32 s75, s67, 229376
    s_add_u32 s75, s75, s71
    buffer_load_dwordx4 v16, s[12:15], s75 offen lds
    buffer_store_dwordx4 v[248:251], v32, s[28:31], s63 offen offset:3072 sc1
    v_mfma_f32_32x32x16_bf16 v[92:107], v[196:199], a[40:43], v[92:107]
    ds_read_b64_tr_b16 v[164:165], v27 offset:36864
    ds_read_b64_tr_b16 v[166:167], v27 offset:37376
    ds_read_b64_tr_b16 v[168:169], v27 offset:38912
    v_mfma_f32_32x32x16_bf16 v[92:107], v[200:203], a[44:47], v[92:107]
    ds_read_b64_tr_b16 v[170:171], v27 offset:39424
    buffer_load_dwordx4 v17, s[12:15], s75 offen offset:1024 lds
    s_add_u32 s67, s67, 1
    s_cmp_eq_u32 s67, 7
    s_cselect_b32 s67, 0, s67
    v_mfma_f32_32x32x16_bf16 v[92:107], v[204:207], a[48:51], v[92:107]
    ds_read_b64_tr_b16 v[172:173], v27 offset:40960
    ds_read_b64_tr_b16 v[174:175], v27 offset:41472
    ds_read_b64_tr_b16 v[176:177], v27 offset:43008
    v_mfma_f32_32x32x16_bf16 v[92:107], v[208:211], a[52:55], v[92:107]
    ds_read_b64_tr_b16 v[178:179], v27 offset:43520
    ds_read_b64_tr_b16 v[180:181], v27 offset:45056
    ds_read_b64_tr_b16 v[182:183], v27 offset:45568
    s_add_u32 m0, s73, 24576
    s_mul_i32 s75, s67, 229376
    s_add_u32 s75, s75, s71
    buffer_load_dwordx4 v16, s[12:15], s75 offen lds
    v_mfma_f32_32x32x16_bf16 v[92:107], v[212:215], a[56:59], v[92:107]
    ds_read_b64_tr_b16 v[184:185], v27 offset:47104
    ds_read_b64_tr_b16 v[186:187], v27 offset:47616
    v_mfma_f32_32x32x16_bf16 v[92:107], v[216:219], a[60:63], v[92:107]
    buffer_load_dwordx4 v17, s[12:15], s75 offen offset:1024 lds
    s_add_u32 s67, s67, 1
    s_cmp_eq_u32 s67, 7
    s_cselect_b32 s67, 0, s67
    s_waitcnt lgkmcnt(8)
    v_mfma_f32_32x32x16_bf16 v[92:107], v[156:159], a[64:67], v[92:107]
    v_mfma_f32_32x32x16_bf16 v[92:107], v[160:163], a[68:71], v[92:107]
    s_waitcnt vmcnt(12) lgkmcnt(0)
    s_barrier
    ds_read_b64_tr_b16 v[188:189], v27 offset:49152
    ds_read_b64_tr_b16 v[190:191], v27 offset:49664
    ds_read_b64_tr_b16 v[192:193], v27 offset:51200
    ds_read_b64_tr_b16 v[194:195], v27 offset:51712
    s_add_u32 m0, s73, 32768
    s_mul_i32 s75, s67, 229376
    s_add_u32 s75, s75, s71
    buffer_load_dwordx4 v16, s[12:15], s75 offen lds
    v_mfma_f32_32x32x16_bf16 v[92:107], v[164:167], a[72:75], v[92:107]
    ds_read_b64_tr_b16 v[196:197], v27 offset:53248
    ds_read_b64_tr_b16 v[198:199], v27 offset:53760
    ds_read_b64_tr_b16 v[200:201], v27 offset:55296
    v_mfma_f32_32x32x16_bf16 v[92:107], v[168:171], a[76:79], v[92:107]
    ds_read_b64_tr_b16 v[202:203], v27 offset:55808
    buffer_load_dwordx4 v17, s[12:15], s75 offen offset:1024 lds
    s_add_u32 s67, s67, 1
    s_cmp_eq_u32 s67, 7
    s_cselect_b32 s67, 0, s67
    v_mfma_f32_32x32x16_bf16 v[92:107], v[172:175], a[80:83], v[92:107]
    v_mfma_f32_32x32x16_bf16 v[92:107], v[176:179], a[84:87], v[92:107]
    s_waitcnt vmcnt(7) lgkmcnt(0)
    s_barrier
    ds_read_b64_tr_b16 v[204:205], v25 offset:0
    ds_read_b64_tr_b16 v[206:207], v25 offset:512
    ds_read_b64_tr_b16 v[208:209], v26 offset:0
    ds_read_b64_tr_b16 v[210:211], v26 offset:512
    s_add_u32 m0, s73, 40960
    s_mul_i32 s75, s67, 229376
    s_add_u32 s75, s75, s71
    buffer_load_dwordx4 v16, s[12:15], s75 offen lds
    v_mfma_f32_32x32x16_bf16 v[92:107], v[180:183], a[88:91], v[92:107]
    ds_read_b64_tr_b16 v[212:213], v25 offset:2048
    ds_read_b64_tr_b16 v[214:215], v25 offset:2560
    ds_read_b64_tr_b16 v[216:217], v26 offset:2048
    v_mfma_f32_32x32x16_bf16 v[92:107], v[184:187], a[92:95], v[92:107]
    ds_read_b64_tr_b16 v[218:219], v26 offset:2560
    buffer_load_dwordx4 v17, s[12:15], s75 offen offset:1024 lds
    s_add_u32 s67, s67, 1
    s_cmp_eq_u32 s67, 7
    s_cselect_b32 s67, 0, s67
    s_mov_b32 s65, 393216
    s_cmp_eq_u64 s[48:49], 0
    s_cselect_b64 exec, 1, s[48:49]
    buffer_load_dword v58, v55, s[28:31], s65 offen sc1
    s_mov_b64 exec, -1
    v_mfma_f32_32x32x16_bf16 v[92:107], v[188:191], a[96:99], v[92:107]
    ds_read_b64_tr_b16 v[156:157], v25 offset:4096
    ds_read_b64_tr_b16 v[158:159], v25 offset:4608
    ds_read_b64_tr_b16 v[160:161], v26 offset:4096
    v_mfma_f32_32x32x16_bf16 v[92:107], v[192:195], a[100:103], v[92:107]
    ds_read_b64_tr_b16 v[162:163], v26 offset:4608
    ds_read_b64_tr_b16 v[164:165], v25 offset:6144
    ds_read_b64_tr_b16 v[166:167], v25 offset:6656
    s_add_u32 m0, s73, 49152
    s_mul_i32 s75, s67, 229376
    s_add_u32 s75, s75, s71
    buffer_load_dwordx4 v16, s[12:15], s75 offen lds
    v_mfma_f32_32x32x16_bf16 v[92:107], v[196:199], a[104:107], v[92:107]
    ds_read_b64_tr_b16 v[168:169], v26 offset:6144
    ds_read_b64_tr_b16 v[170:171], v26 offset:6656
    v_mfma_f32_32x32x16_bf16 v[92:107], v[200:203], a[108:111], v[92:107]
    buffer_load_dwordx4 v17, s[12:15], s75 offen offset:1024 lds
    s_add_u32 s67, s67, 1
    s_cmp_eq_u32 s67, 7
    s_cselect_b32 s67, 0, s67
    s_waitcnt lgkmcnt(8)
    v_mfma_f32_32x32x16_bf16 v[60:75], v[204:207], a[0:3], 0
    ds_read_b64_tr_b16 v[172:173], v25 offset:8192
    ds_read_b64_tr_b16 v[174:175], v25 offset:8704
    ds_read_b64_tr_b16 v[176:177], v26 offset:8192
    s_mul_i32 s63, s60, 114688
    s_and_b32 s64, s57, 8
    s_lshl_b32 s64, s64, 8
    s_add_u32 s64, s64, 110592
    s_add_u32 s63, s63, s64
    s_add_u32 s63, s63, 7340032
    v_cvt_pk_bf16_f32 v220, v92, v93
    v_cvt_pk_bf16_f32 v221, v94, v95
    v_cvt_pk_bf16_f32 v222, v96, v97
    v_mfma_f32_32x32x16_bf16 v[76:91], v[208:211], a[0:3], 0
    ds_read_b64_tr_b16 v[178:179], v26 offset:8704
    ds_read_b64_tr_b16 v[180:181], v25 offset:10240
    ds_read_b64_tr_b16 v[182:183], v25 offset:10752
    v_cvt_pk_bf16_f32 v223, v98, v99
    v_pk_max_i16 v220, v220, 0
    v_pk_max_i16 v221, v221, 0
    v_pk_max_i16 v222, v222, 0
    v_mfma_f32_32x32x16_bf16 v[60:75], v[212:215], a[4:7], v[60:75]
    ds_read_b64_tr_b16 v[184:185], v26 offset:10240
    ds_read_b64_tr_b16 v[186:187], v26 offset:10752
    v_pk_max_i16 v223, v223, 0
    buffer_store_dwordx4 v[220:223], v32, s[28:31], s63 offen offset:0 sc1
    v_cvt_pk_bf16_f32 v224, v100, v101
    v_cvt_pk_bf16_f32 v225, v102, v103
    v_mfma_f32_32x32x16_bf16 v[76:91], v[216:219], a[4:7], v[76:91]
    v_cvt_pk_bf16_f32 v226, v104, v105
    v_cvt_pk_bf16_f32 v227, v106, v107
    v_pk_max_i16 v224, v224, 0
    v_pk_max_i16 v225, v225, 0
    s_waitcnt lgkmcnt(8)
    v_mfma_f32_32x32x16_bf16 v[60:75], v[156:159], a[8:11], v[60:75]
    ds_read_b64_tr_b16 v[188:189], v25 offset:12288
    ds_read_b64_tr_b16 v[190:191], v25 offset:12800
    ds_read_b64_tr_b16 v[192:193], v26 offset:12288
    v_pk_max_i16 v226, v226, 0
    v_pk_max_i16 v227, v227, 0
    buffer_store_dwordx4 v[224:227], v32, s[28:31], s63 offen offset:1024 sc1
    v_mfma_f32_32x32x16_bf16 v[76:91], v[160:163], a[8:11], v[76:91]
    ds_read_b64_tr_b16 v[194:195], v26 offset:12800
    ds_read_b64_tr_b16 v[196:197], v25 offset:14336
    ds_read_b64_tr_b16 v[198:199], v25 offset:14848
    v_mfma_f32_32x32x16_bf16 v[60:75], v[164:167], a[12:15], v[60:75]
    ds_read_b64_tr_b16 v[200:201], v26 offset:14336
    ds_read_b64_tr_b16 v[202:203], v26 offset:14848
    v_mfma_f32_32x32x16_bf16 v[76:91], v[168:171], a[12:15], v[76:91]
    s_waitcnt lgkmcnt(8)
    v_mfma_f32_32x32x16_bf16 v[60:75], v[172:175], a[16:19], v[60:75]
    v_mfma_f32_32x32x16_bf16 v[76:91], v[176:179], a[16:19], v[76:91]
    s_waitcnt vmcnt(9) lgkmcnt(0)
    s_barrier
    ds_read_b64_tr_b16 v[204:205], v25 offset:16384
    ds_read_b64_tr_b16 v[206:207], v25 offset:16896
    ds_read_b64_tr_b16 v[208:209], v26 offset:16384
    ds_read_b64_tr_b16 v[210:211], v26 offset:16896
    v_mfma_f32_32x32x16_bf16 v[60:75], v[180:183], a[20:23], v[60:75]
    ds_read_b64_tr_b16 v[212:213], v25 offset:18432
    ds_read_b64_tr_b16 v[214:215], v25 offset:18944
    ds_read_b64_tr_b16 v[216:217], v26 offset:18432
    v_mfma_f32_32x32x16_bf16 v[76:91], v[184:187], a[20:23], v[76:91]
    ds_read_b64_tr_b16 v[218:219], v26 offset:18944
    s_mov_b32 s61, 393216
    s_mov_b64 exec, 2
    buffer_store_dword v20, v29, s[28:31], s61 offen sc1
    s_mov_b64 exec, -1
    s_waitcnt vmcnt(5)
    v_cmp_ne_u32 vcc, v58, v20
    s_nop 1
    s_and_b64 s[86:87], vcc, s[48:49]
    s_cbranch_scc0 L_pollok_4
    s_mov_b32 s65, 0
    s_mov_b32 s61, 393216
L_poll_3:
    s_mov_b64 exec, s[86:87]
    buffer_load_dword v58, v55, s[28:31], s61 offen sc1
    s_mov_b64 exec, -1
    s_waitcnt vmcnt(0)
    v_cmp_ne_u32 vcc, v58, v20
    s_add_u32 s65, s65, 1
    s_nop 0
    s_and_b64 s[86:87], vcc, s[48:49]
    s_cbranch_scc0 L_pollok_4
    s_cmp_lt_u32 s65, 20000
    s_cbranch_scc1 L_poll_3
L_pollok_4:
    v_mfma_f32_32x32x16_bf16 v[60:75], v[188:191], a[24:27], v[60:75]
    ds_read_b64_tr_b16 v[156:157], v25 offset:20480
    ds_read_b64_tr_b16 v[158:159], v25 offset:20992
    ds_read_b64_tr_b16 v[160:161], v26 offset:20480
    v_mfma_f32_32x32x16_bf16 v[76:91], v[192:195], a[24:27], v[76:91]
    ds_read_b64_tr_b16 v[162:163], v26 offset:20992
    ds_read_b64_tr_b16 v[164:165], v25 offset:22528
    ds_read_b64_tr_b16 v[166:167], v25 offset:23040
    s_mul_i32 s47, s84, 448
    s_add_u32 s47, s47, 1048576
    s_mul_i32 s85, s83, 86016
    s_add_u32 s85, s85, s47
    s_add_u32 m0, s45, 8192
    s_nop 0
    buffer_load_dwordx4 v44, s[28:31], s85 offen offset:0 sc1 lds
    v_mfma_f32_32x32x16_bf16 v[60:75], v[196:199], a[28:31], v[60:75]
    ds_read_b64_tr_b16 v[168:169], v26 offset:22528
    ds_read_b64_tr_b16 v[170:171], v26 offset:23040
    v_mfma_f32_32x32x16_bf16 v[76:91], v[200:203], a[28:31], v[76:91]
    buffer_load_dwordx4 v45, s[28:31], s85 offen offset:1024 sc1 lds
    s_waitcnt lgkmcnt(8)
    v_mfma_f32_32x32x16_bf16 v[60:75], v[204:207], a[32:35], v[60:75]
    ds_read_b64_tr_b16 v[172:173], v25 offset:24576
    ds_read_b64_tr_b16 v[174:175], v25 offset:25088
    ds_read_b64_tr_b16 v[176:177], v26 offset:24576
    v_mfma_f32_32x32x16_bf16 v[76:91], v[208:211], a[32:35], v[76:91]
    ds_read_b64_tr_b16 v[178:179], v26 offset:25088
    ds_read_b64_tr_b16 v[180:181], v25 offset:26624
    ds_read_b64_tr_b16 v[182:183], v25 offset:27136
    s_mul_i32 s85, s3, 6144
    s_add_u32 m0, s85, 65536
    s_add_i32 s85, s81, 0
    s_max_i32 s85, s85, 0
    s_mul_i32 s85, s85, 86016
    s_add_u32 s85, s85, s47
    s_add_u32 s85, s85, 7168
    buffer_load_dwordx4 v44, s[28:31], s85 offen offset:0 sc1 lds
    v_mfma_f32_32x32x16_bf16 v[60:75], v[212:215], a[36:39], v[60:75]
    ds_read_b64_tr_b16 v[184:185], v26 offset:26624
    ds_read_b64_tr_b16 v[186:187], v26 offset:27136
    v_mfma_f32_32x32x16_bf16 v[76:91], v[216:219], a[36:39], v[76:91]
    buffer_load_dwordx4 v45, s[28:31], s85 offen offset:1024 sc1 lds
    s_waitcnt lgkmcnt(8)
    v_mfma_f32_32x32x16_bf16 v[60:75], v[156:159], a[40:43], v[60:75]
    ds_read_b64_tr_b16 v[188:189], v25 offset:28672
    ds_read_b64_tr_b16 v[190:191], v25 offset:29184
    ds_read_b64_tr_b16 v[192:193], v26 offset:28672
    v_mfma_f32_32x32x16_bf16 v[76:91], v[160:163], a[40:43], v[76:91]
    ds_read_b64_tr_b16 v[194:195], v26 offset:29184
    ds_read_b64_tr_b16 v[196:197], v25 offset:30720
    ds_read_b64_tr_b16 v[198:199], v25 offset:31232
    s_mul_i32 s85, s3, 6144
    s_add_u32 m0, s85, 67584
    s_add_i32 s85, s81, 1
    s_max_i32 s85, s85, 0
    s_mul_i32 s85, s85, 86016
    s_add_u32 s85, s85, s47
    s_add_u32 s85, s85, 7168
    buffer_load_dwordx4 v44, s[28:31], s85 offen offset:0 sc1 lds
    v_mfma_f32_32x32x16_bf16 v[60:75], v[164:167], a[44:47], v[60:75]
    ds_read_b64_tr_b16 v[200:201], v26 offset:30720
    ds_read_b64_tr_b16 v[202:203], v26 offset:31232
    v_mfma_f32_32x32x16_bf16 v[76:91], v[168:171], a[44:47], v[76:91]
    buffer_load_dwordx4 v45, s[28:31], s85 offen offset:1024 sc1 lds
    s_waitcnt lgkmcnt(8)
    v_mfma_f32_32x32x16_bf16 v[60:75], v[172:175], a[48:51], v[60:75]
    v_mfma_f32_32x32x16_bf16 v[76:91], v[176:179], a[48:51], v[76:91]
    s_waitcnt lgkmcnt(0)
    s_barrier
    ds_read_b64_tr_b16 v[204:205], v25 offset:32768
    ds_read_b64_tr_b16 v[206:207], v25 offset:33280
    ds_read_b64_tr_b16 v[208:209], v26 offset:32768
    ds_read_b64_tr_b16 v[210:211], v26 offset:33280
    s_mul_i32 s85, s3, 6144
    s_add_u32 m0, s85, 69632
    s_add_i32 s85, s81, 2
    s_max_i32 s85, s85, 0
    s_mul_i32 s85, s85, 86016
    s_add_u32 s85, s85, s47
    s_add_u32 s85, s85, 7168
    buffer_load_dwordx4 v44, s[28:31], s85 offen offset:0 sc1 lds
    v_mfma_f32_32x32x16_bf16 v[60:75], v[180:183], a[52:55], v[60:75]
    ds_read_b64_tr_b16 v[212:213], v25 offset:34816
    ds_read_b64_tr_b16 v[214:215], v25 offset:35328
    ds_read_b64_tr_b16 v[216:217], v26 offset:34816
    v_mfma_f32_32x32x16_bf16 v[76:91], v[184:187], a[52:55], v[76:91]
    ds_read_b64_tr_b16 v[218:219], v26 offset:35328
    buffer_load_dwordx4 v45, s[28:31], s85 offen offset:1024 sc1 lds
    v_mfma_f32_32x32x16_bf16 v[60:75], v[188:191], a[56:59], v[60:75]
    ds_read_b64_tr_b16 v[156:157], v25 offset:36864
    ds_read_b64_tr_b16 v[158:159], v25 offset:37376
    ds_read_b64_tr_b16 v[160:161], v26 offset:36864
    v_mfma_f32_32x32x16_bf16 v[76:91], v[192:195], a[56:59], v[76:91]
    ds_read_b64_tr_b16 v[162:163], v26 offset:37376
    ds_read_b64_tr_b16 v[164:165], v25 offset:38912
    ds_read_b64_tr_b16 v[166:167], v25 offset:39424
    v_mfma_f32_32x32x16_bf16 v[60:75], v[196:199], a[60:63], v[60:75]
    ds_read_b64_tr_b16 v[168:169], v26 offset:38912
    ds_read_b64_tr_b16 v[170:171], v26 offset:39424
    v_mfma_f32_32x32x16_bf16 v[76:91], v[200:203], a[60:63], v[76:91]
    s_waitcnt lgkmcnt(8)
    v_mfma_f32_32x32x16_bf16 v[60:75], v[204:207], a[64:67], v[60:75]
    ds_read_b64_tr_b16 v[172:173], v25 offset:40960
    ds_read_b64_tr_b16 v[174:175], v25 offset:41472
    ds_read_b64_tr_b16 v[176:177], v26 offset:40960
    v_mfma_f32_32x32x16_bf16 v[76:91], v[208:211], a[64:67], v[76:91]
    ds_read_b64_tr_b16 v[178:179], v26 offset:41472
    ds_read_b64_tr_b16 v[180:181], v25 offset:43008
    ds_read_b64_tr_b16 v[182:183], v25 offset:43520
    v_mfma_f32_32x32x16_bf16 v[60:75], v[212:215], a[68:71], v[60:75]
    ds_read_b64_tr_b16 v[184:185], v26 offset:43008
    ds_read_b64_tr_b16 v[186:187], v26 offset:43520
    v_mfma_f32_32x32x16_bf16 v[76:91], v[216:219], a[68:71], v[76:91]
    s_waitcnt lgkmcnt(8)
    v_mfma_f32_32x32x16_bf16 v[60:75], v[156:159], a[72:75], v[60:75]
    ds_read_b64_tr_b16 v[188:189], v25 offset:45056
    ds_read_b64_tr_b16 v[190:191], v25 offset:45568
    ds_read_b64_tr_b16 v[192:193], v26 offset:45056
    v_mfma_f32_32x32x16_bf16 v[76:91], v[160:163], a[72:75], v[76:91]
    ds_read_b64_tr_b16 v[194:195], v26 offset:45568
    ds_read_b64_tr_b16 v[196:197], v25 offset:47104
    ds_read_b64_tr_b16 v[198:199], v25 offset:47616
    v_mfma_f32_32x32x16_bf16 v[60:75], v[164:167], a[76:79], v[60:75]
    ds_read_b64_tr_b16 v[200:201], v26 offset:47104
    ds_read_b64_tr_b16 v[202:203], v26 offset:47616
    v_mfma_f32_32x32x16_bf16 v[76:91], v[168:171], a[76:79], v[76:91]
    s_waitcnt lgkmcnt(8)
    v_mfma_f32_32x32x16_bf16 v[60:75], v[172:175], a[80:83], v[60:75]
    v_mfma_f32_32x32x16_bf16 v[76:91], v[176:179], a[80:83], v[76:91]
    s_waitcnt vmcnt(11) lgkmcnt(0)
    s_barrier
    ds_read_b64_tr_b16 v[204:205], v25 offset:49152
    ds_read_b64_tr_b16 v[206:207], v25 offset:49664
    ds_read_b64_tr_b16 v[208:209], v26 offset:49152
    ds_read_b64_tr_b16 v[210:211], v26 offset:49664
    v_mfma_f32_32x32x16_bf16 v[60:75], v[180:183], a[84:87], v[60:75]
    ds_read_b64_tr_b16 v[212:213], v25 offset:51200
    ds_read_b64_tr_b16 v[214:215], v25 offset:51712
    ds_read_b64_tr_b16 v[216:217], v26 offset:51200
    v_mfma_f32_32x32x16_bf16 v[76:91], v[184:187], a[84:87], v[76:91]
    ds_read_b64_tr_b16 v[218:219], v26 offset:51712
    v_mfma_f32_32x32x16_bf16 v[60:75], v[188:191], a[88:91], v[60:75]
    ds_read_b64_tr_b16 v[156:157], v25 offset:53248
    ds_read_b64_tr_b16 v[158:159], v25 offset:53760
    ds_read_b64_tr_b16 v[160:161], v26 offset:53248
    v_mfma_f32_32x32x16_bf16 v[76:91], v[192:195], a[88:91], v[76:91]
    ds_read_b64_tr_b16 v[162:163], v26 offset:53760
    ds_read_b64_tr_b16 v[164:165], v25 offset:55296
    ds_read_b64_tr_b16 v[166:167], v25 offset:55808
    v_mfma_f32_32x32x16_bf16 v[60:75], v[196:199], a[92:95], v[60:75]
    ds_read_b64_tr_b16 v[168:169], v26 offset:55296
    ds_read_b64_tr_b16 v[170:171], v26 offset:55808
    v_mfma_f32_32x32x16_bf16 v[76:91], v[200:203], a[92:95], v[76:91]
    s_waitcnt vmcnt(9)
    s_mov_b32 s61, 393216
    s_mov_b64 exec, 32
    buffer_store_dword v20, v29, s[28:31], s61 offen sc1
    s_mov_b64 exec, -1
    s_waitcnt lgkmcnt(8)
    v_mfma_f32_32x32x16_bf16 v[60:75], v[204:207], a[96:99], v[60:75]
    ds_read_b128 v[172:175], v10 offset:0
    ds_read_b128 v[176:179], v10 offset:32
    ds_read_b128 v[180:183], v10 offset:64
    v_mfma_f32_32x32x16_bf16 v[76:91], v[208:211], a[96:99], v[76:91]
    ds_read_b128 v[184:187], v10 offset:96
    v_mfma_f32_32x32x16_bf16 v[60:75], v[212:215], a[100:103], v[60:75]
    v_mfma_f32_32x32x16_bf16 v[76:91], v[216:219], a[100:103], v[76:91]
    s_waitcnt lgkmcnt(4)
    v_mfma_f32_32x32x16_bf16 v[60:75], v[156:159], a[104:107], v[60:75]
    ds_read_b128 v[188:191], v10 offset:128
    ds_read_b128 v[192:195], v10 offset:160
    ds_read_b128 v[196:199], v10 offset:192
    v_mfma_f32_32x32x16_bf16 v[76:91], v[160:163], a[104:107], v[76:91]
    ds_read_b128 v[200:203], v10 offset:224
    v_mfma_f32_32x32x16_bf16 v[60:75], v[164:167], a[108:111], v[60:75]
    v_mfma_f32_32x32x16_bf16 v[76:91], v[168:171], a[108:111], v[76:91]
    s_mov_b32 s65, 393216
    s_cmp_eq_u64 s[50:51], 0
    s_cselect_b64 exec, 1, s[50:51]
    buffer_load_dword v58, v55, s[28:31], s65 offen sc1
    s_mov_b64 exec, -1
    s_waitcnt lgkmcnt(4)
    v_mfma_f32_32x32x16_bf16 v[108:123], v[172:175], a[0:3], 0
    ds_read_b128 v[204:207], v10 offset:256
    ds_read_b128 v[208:211], v10 offset:288
    ds_read_b128 v[212:215], v10 offset:320
    s_mul_i32 s63, s60, 114688
    s_lshl_b32 s64, s78, 12
    s_add_u32 s63, s63, s64
    s_add_u32 s63, s63, 7340032
    v_cvt_pk_bf16_f32 v220, v60, v61
    v_cvt_pk_bf16_f32 v221, v62, v63
    v_cvt_pk_bf16_f32 v222, v64, v65
    v_mfma_f32_32x32x16_bf16 v[108:123], v[176:179], a[4:7], v[108:123]
    ds_read_b128 v[216:219], v10 offset:352
    v_cvt_pk_bf16_f32 v223, v66, v67
    v_pk_max_i16 v220, v220, 0
    v_pk_max_i16 v221, v221, 0
    v_pk_max_i16 v222, v222, 0
    v_mfma_f32_32x32x16_bf16 v[108:123], v[180:183], a[8:11], v[108:123]
    v_pk_max_i16 v223, v223, 0
    buffer_store_dwordx4 v[220:223], v32, s[28:31], s63 offen offset:0 sc1
    v_cvt_pk_bf16_f32 v224, v68, v69
    v_cvt_pk_bf16_f32 v225, v70, v71
    v_mfma_f32_32x32x16_bf16 v[108:123], v[184:187], a[12:15], v[108:123]
    v_cvt_pk_bf16_f32 v226, v72, v73
    v_cvt_pk_bf16_f32 v227, v74, v75
    v_pk_max_i16 v224, v224, 0
    v_pk_max_i16 v225, v225, 0
    s_waitcnt lgkmcnt(4)
    v_mfma_f32_32x32x16_bf16 v[108:123], v[188:191], a[16:19], v[108:123]
    ds_read_b128 v[156:159], v10 offset:384
    ds_read_b128 v[160:163], v10 offset:416
    ds_read_b128 v[164:167], v10 offset:448
    v_pk_max_i16 v226, v226, 0
    v_pk_max_i16 v227, v227, 0
    buffer_store_dwordx4 v[224:227], v32, s[28:31], s63 offen offset:1024 sc1
    v_cvt_pk_bf16_f32 v228, v76, v77
    v_mfma_f32_32x32x16_bf16 v[108:123], v[192:195], a[20:23], v[108:123]
    ds_read_b128 v[168:171], v10 offset:480
    v_cvt_pk_bf16_f32 v229, v78, v79
    v_cvt_pk_bf16_f32 v230, v80, v81
    v_cvt_pk_bf16_f32 v231, v82, v83
    v_pk_max_i16 v228, v228, 0
    v_mfma_f32_32x32x16_bf16 v[108:123], v[196:199], a[24:27], v[108:123]
    v_pk_max_i16 v229, v229, 0
    v_pk_max_i16 v230, v230, 0
    v_pk_max_i16 v231, v231, 0
    buffer_store_dwordx4 v[228:231], v32, s[28:31], s63 offen offset:2048 sc1
    v_mfma_f32_32x32x16_bf16 v[108:123], v[200:203], a[28:31], v[108:123]
    v_cvt_pk_bf16_f32 v232, v84, v85
    v_cvt_pk_bf16_f32 v233, v86, v87
    v_cvt_pk_bf16_f32 v234, v88, v89
    v_cvt_pk_bf16_f32 v235, v90, v91
    s_waitcnt lgkmcnt(4)
    v_mfma_f32_32x32x16_bf16 v[108:123], v[204:207], a[32:35], v[108:123]
    ds_read_b128 v[172:175], v10 offset:512
    ds_read_b128 v[176:179], v10 offset:544
    ds_read_b128 v[180:183], v10 offset:576
    v_pk_max_i16 v232, v232, 0
    v_pk_max_i16 v233, v233, 0
    v_pk_max_i16 v234, v234, 0
    v_pk_max_i16 v235, v235, 0
    v_mfma_f32_32x32x16_bf16 v[108:123], v[208:211], a[36:39], v[108:123]
    ds_read_b128 v[184:187], v10 offset:608
    buffer_store_dwordx4 v[232:235], v32, s[28:31], s63 offen offset:3072 sc1
    v_mfma_f32_32x32x16_bf16 v[108:123], v[212:215], a[40:43], v[108:123]
    v_mfma_f32_32x32x16_bf16 v[108:123], v[216:219], a[44:47], v[108:123]
    s_waitcnt lgkmcnt(4)
    v_mfma_f32_32x32x16_bf16 v[108:123], v[156:159], a[48:51], v[108:123]
    ds_read_b128 v[188:191], v10 offset:640
    ds_read_b128 v[192:195], v10 offset:672
    ds_read_b128 v[196:199], v10 offset:704
    v_mfma_f32_32x32x16_bf16 v[108:123], v[160:163], a[52:55], v[108:123]
    ds_read_b128 v[200:203], v10 offset:736
    v_mfma_f32_32x32x16_bf16 v[108:123], v[164:167], a[56:59], v[108:123]
    v_mfma_f32_32x32x16_bf16 v[108:123], v[168:171], a[60:63], v[108:123]
    s_waitcnt lgkmcnt(4)
    v_mfma_f32_32x32x16_bf16 v[108:123], v[172:175], a[64:67], v[108:123]
    ds_read_b128 v[204:207], v10 offset:768
    ds_read_b128 v[208:211], v10 offset:800
    ds_read_b128 v[212:215], v10 offset:832
    v_mfma_f32_32x32x16_bf16 v[108:123], v[176:179], a[68:71], v[108:123]
    ds_read_b128 v[216:219], v10 offset:864
    v_mfma_f32_32x32x16_bf16 v[108:123], v[180:183], a[72:75], v[108:123]
    v_mfma_f32_32x32x16_bf16 v[108:123], v[184:187], a[76:79], v[108:123]
    s_waitcnt lgkmcnt(4)
    v_mfma_f32_32x32x16_bf16 v[108:123], v[188:191], a[80:83], v[108:123]
    v_mfma_f32_32x32x16_bf16 v[108:123], v[192:195], a[84:87], v[108:123]
    v_mfma_f32_32x32x16_bf16 v[108:123], v[196:199], a[88:91], v[108:123]
    v_mfma_f32_32x32x16_bf16 v[108:123], v[200:203], a[92:95], v[108:123]
    s_waitcnt lgkmcnt(0)
    v_mfma_f32_32x32x16_bf16 v[108:123], v[204:207], a[96:99], v[108:123]
    v_mfma_f32_32x32x16_bf16 v[108:123], v[208:211], a[100:103], v[108:123]
    v_mfma_f32_32x32x16_bf16 v[108:123], v[212:215], a[104:107], v[108:123]
    v_mfma_f32_32x32x16_bf16 v[108:123], v[216:219], a[108:111], v[108:123]
    s_nop 11
    v_cvt_pk_bf16_f32 v2, v108, v108
    v_and_b32 v2, 0xffff0000, v2
    v_mul_f32 v2, 0xbfb8aa3b, v2
    v_exp_f32 v2, v2
    s_nop 0
    v_add_f32 v2, 1.0, v2
    v_rcp_f32 v2, v2
    s_nop 0
    v_cvt_pk_bf16_f32 v2, v2, v2
    v_and_b32 v4, 0xffff0000, v2
    v_sub_f32 v2, 1.0, v4
    v_cvt_pk_bf16_f32 v2, v2, v2
    v_and_b32 v5, 0xffff0000, v2
    v_cmp_eq_u32 vcc, 0, v7
    v_lshlrev_b32 v2, 13, v7
    v_lshl_add_u32 v2, v8, 2, v2
    v_cndmask_b32 v5, v5, v4, vcc
    s_lshl_b32 s63, s60, 7
    s_add_u32 s63, s63, 24576
    buffer_store_dword v5, v2, s[28:31], s63 offen sc1
    v_mov_b32 v11, v2
    v_mov_b32 v252, 0x3f803f80
    v_mov_b32 v253, 0x3f803f80
    v_mov_b32 v254, 0x3f803f80
    v_mov_b32 v255, 0x3f803f80
    s_waitcnt vmcnt(7)
    s_branch L_p2
L_qq:
    s_waitcnt lgkmcnt(8)
    v_mfma_f32_32x32x16_bf16 v[124:139], a[0:3], v[188:191], 0
    ds_read_b64_tr_b16 v[156:157], v25 offset:8192
    ds_read_b64_tr_b16 v[158:159], v25 offset:8704
    ds_read_b64_tr_b16 v[160:161], v26 offset:8192
    s_cmp_lt_u32 s57, 7
    s_cselect_b32 s86, 0x3e8b97f6, 1.0
    s_mov_b32 s87, s86
    s_mul_i32 s63, s60, 86016
    s_lshl_b32 s64, s57, 10
    s_add_u32 s63, s63, s64
    s_add_u32 s63, s63, 1048576
    s_add_u32 s64, s63, 43008
    v_pk_mul_f32 v[60:61], v[60:61], s[86:87]
    v_pk_mul_f32 v[62:63], v[62:63], s[86:87]
    v_mfma_f32_32x32x16_bf16 v[140:155], a[0:3], v[192:195], 0
    ds_read_b64_tr_b16 v[162:163], v26 offset:8704
    ds_read_b64_tr_b16 v[164:165], v25 offset:10240
    ds_read_b64_tr_b16 v[166:167], v25 offset:10752
    v_pk_mul_f32 v[64:65], v[64:65], s[86:87]
    v_pk_mul_f32 v[66:67], v[66:67], s[86:87]
    v_cvt_pk_bf16_f32 v220, v60, v61
    v_cvt_pk_bf16_f32 v221, v62, v63
    v_mfma_f32_32x32x16_bf16 v[124:139], a[4:7], v[196:199], v[124:139]
    ds_read_b64_tr_b16 v[168:169], v26 offset:10240
    ds_read_b64_tr_b16 v[170:171], v26 offset:10752
    v_cvt_pk_bf16_f32 v222, v64, v65
    v_cvt_pk_bf16_f32 v223, v66, v67
    buffer_store_dwordx4 v[220:223], v28, s[28:31], s63 offen offset:0 sc1
    v_pk_mul_f32 v[68:69], v[68:69], s[86:87]
    v_mfma_f32_32x32x16_bf16 v[140:155], a[4:7], v[200:203], v[140:155]
    v_pk_mul_f32 v[70:71], v[70:71], s[86:87]
    v_pk_mul_f32 v[72:73], v[72:73], s[86:87]
    v_pk_mul_f32 v[74:75], v[74:75], s[86:87]
    v_cvt_pk_bf16_f32 v224, v68, v69
    s_waitcnt lgkmcnt(8)
    v_mfma_f32_32x32x16_bf16 v[124:139], a[8:11], v[204:207], v[124:139]
    ds_read_b64_tr_b16 v[172:173], v25 offset:12288
    ds_read_b64_tr_b16 v[174:175], v25 offset:12800
    ds_read_b64_tr_b16 v[176:177], v26 offset:12288
    v_cvt_pk_bf16_f32 v225, v70, v71
    v_cvt_pk_bf16_f32 v226, v72, v73
    v_cvt_pk_bf16_f32 v227, v74, v75
    buffer_store_dwordx4 v[224:227], v28, s[28:31], s64 offen offset:0 sc1
    v_mfma_f32_32x32x16_bf16 v[140:155], a[8:11], v[208:211], v[140:155]
    ds_read_b64_tr_b16 v[178:179], v26 offset:12800
    ds_read_b64_tr_b16 v[180:181], v25 offset:14336
    ds_read_b64_tr_b16 v[182:183], v25 offset:14848
    v_pk_mul_f32 v[76:77], v[76:77], s[86:87]
    v_pk_mul_f32 v[78:79], v[78:79], s[86:87]
    v_pk_mul_f32 v[80:81], v[80:81], s[86:87]
    v_pk_mul_f32 v[82:83], v[82:83], s[86:87]
    v_mfma_f32_32x32x16_bf16 v[124:139], a[12:15], v[212:215], v[124:139]
    ds_read_b64_tr_b16 v[184:185], v26 offset:14336
    ds_read_b64_tr_b16 v[186:187], v26 offset:14848
    v_cvt_pk_bf16_f32 v228, v76, v77
    v_cvt_pk_bf16_f32 v229, v78, v79
    v_cvt_pk_bf16_f32 v230, v80, v81
    v_cvt_pk_bf16_f32 v231, v82, v83
    v_mfma_f32_32x32x16_bf16 v[140:155], a[12:15], v[216:219], v[140:155]
    buffer_store_dwordx4 v[228:231], v28, s[28:31], s63 offen offset:512 sc1
    v_pk_mul_f32 v[84:85], v[84:85], s[86:87]
    v_pk_mul_f32 v[86:87], v[86:87], s[86:87]
    v_pk_mul_f32 v[88:89], v[88:89], s[86:87]
    s_waitcnt lgkmcnt(8)
    v_mfma_f32_32x32x16_bf16 v[124:139], a[16:19], v[156:159], v[124:139]
    v_pk_mul_f32 v[90:91], v[90:91], s[86:87]
    v_cvt_pk_bf16_f32 v232, v84, v85
    v_cvt_pk_bf16_f32 v233, v86, v87
    v_cvt_pk_bf16_f32 v234, v88, v89
    v_mfma_f32_32x32x16_bf16 v[140:155], a[16:19], v[160:163], v[140:155]
    s_waitcnt vmcnt(9) lgkmcnt(0)
    s_barrier
    ds_read_b64_tr_b16 v[188:189], v25 offset:16384
    ds_read_b64_tr_b16 v[190:191], v25 offset:16896
    ds_read_b64_tr_b16 v[192:193], v26 offset:16384
    ds_read_b64_tr_b16 v[194:195], v26 offset:16896
    s_mul_i32 s71, s3, 57344
    s_lshl_b32 s75, s78, 7
    s_add_u32 s71, s71, s75
    s_add_u32 m0, s73, 0
    s_mul_i32 s75, s67, 229376
    s_add_u32 s75, s75, s71
    buffer_load_dwordx4 v16, s[12:15], s75 offen lds
    v_cvt_pk_bf16_f32 v235, v90, v91
    buffer_store_dwordx4 v[232:235], v28, s[28:31], s64 offen offset:512 sc1
    v_mfma_f32_32x32x16_bf16 v[124:139], a[20:23], v[164:167], v[124:139]
    ds_read_b64_tr_b16 v[196:197], v25 offset:18432
    ds_read_b64_tr_b16 v[198:199], v25 offset:18944
    ds_read_b64_tr_b16 v[200:201], v26 offset:18432
    v_mfma_f32_32x32x16_bf16 v[140:155], a[20:23], v[168:171], v[140:155]
    ds_read_b64_tr_b16 v[202:203], v26 offset:18944
    buffer_load_dwordx4 v17, s[12:15], s75 offen offset:1024 lds
    s_add_u32 s67, s67, 1
    s_cmp_eq_u32 s67, 7
    s_cselect_b32 s67, 0, s67
    v_mfma_f32_32x32x16_bf16 v[124:139], a[24:27], v[172:175], v[124:139]
    ds_read_b64_tr_b16 v[204:205], v25 offset:20480
    ds_read_b64_tr_b16 v[206:207], v25 offset:20992
    ds_read_b64_tr_b16 v[208:209], v26 offset:20480
    v_mfma_f32_32x32x16_bf16 v[140:155], a[24:27], v[176:179], v[140:155]
    ds_read_b64_tr_b16 v[210:211], v26 offset:20992
    ds_read_b64_tr_b16 v[212:213], v25 offset:22528
    ds_read_b64_tr_b16 v[214:215], v25 offset:23040
    s_add_u32 m0, s73, 8192
    s_mul_i32 s75, s67, 229376
    s_add_u32 s75, s75, s71
    buffer_load_dwordx4 v16, s[12:15], s75 offen lds
    v_mfma_f32_32x32x16_bf16 v[124:139], a[28:31], v[180:183], v[124:139]
    ds_read_b64_tr_b16 v[216:217], v26 offset:22528
    ds_read_b64_tr_b16 v[218:219], v26 offset:23040
    v_mfma_f32_32x32x16_bf16 v[140:155], a[28:31], v[184:187], v[140:155]
    buffer_load_dwordx4 v17, s[12:15], s75 offen offset:1024 lds
    s_add_u32 s67, s67, 1
    s_cmp_eq_u32 s67, 7
    s_cselect_b32 s67, 0, s67
    s_waitcnt lgkmcnt(8)
    v_mfma_f32_32x32x16_bf16 v[124:139], a[32:35], v[188:191], v[124:139]
    ds_read_b64_tr_b16 v[156:157], v25 offset:24576
    ds_read_b64_tr_b16 v[158:159], v25 offset:25088
    ds_read_b64_tr_b16 v[160:161], v26 offset:24576
    v_mfma_f32_32x32x16_bf16 v[140:155], a[32:35], v[192:195], v[140:155]
    ds_read_b64_tr_b16 v[162:163], v26 offset:25088
    ds_read_b64_tr_b16 v[164:165], v25 offset:26624
    ds_read_b64_tr_b16 v[166:167], v25 offset:27136
    v_mfma_f32_32x32x16_bf16 v[124:139], a[36:39], v[196:199], v[124:139]
    ds_read_b64_tr_b16 v[168:169], v26 offset:26624
    ds_read_b64_tr_b16 v[170:171], v26 offset:27136
    v_mfma_f32_32x32x16_bf16 v[140:155], a[36:39], v[200:203], v[140:155]
    s_waitcnt lgkmcnt(8)
    v_mfma_f32_32x32x16_bf16 v[124:139], a[40:43], v[204:207], v[124:139]
    ds_read_b64_tr_b16 v[172:173], v25 offset:28672
    ds_read_b64_tr_b16 v[174:175], v25 offset:29184
    ds_read_b64_tr_b16 v[176:177], v26 offset:28672
    v_mfma_f32_32x32x16_bf16 v[140:155], a[40:43], v[208:211], v[140:155]
    ds_read_b64_tr_b16 v[178:179], v26 offset:29184
    ds_read_b64_tr_b16 v[180:181], v25 offset:30720
    ds_read_b64_tr_b16 v[182:183], v25 offset:31232
    v_mfma_f32_32x32x16_bf16 v[124:139], a[44:47], v[212:215], v[124:139]
    ds_read_b64_tr_b16 v[184:185], v26 offset:30720
    ds_read_b64_tr_b16 v[186:187], v26 offset:31232
    v_mfma_f32_32x32x16_bf16 v[140:155], a[44:47], v[216:219], v[140:155]
    s_waitcnt lgkmcnt(8)
    v_mfma_f32_32x32x16_bf16 v[124:139], a[48:51], v[156:159], v[124:139]
    v_mfma_f32_32x32x16_bf16 v[140:155], a[48:51], v[160:163], v[140:155]
    s_waitcnt vmcnt(10) lgkmcnt(0)
    s_barrier
    ds_read_b64_tr_b16 v[188:189], v25 offset:32768
    ds_read_b64_tr_b16 v[190:191], v25 offset:33280
    ds_read_b64_tr_b16 v[192:193], v26 offset:32768
    ds_read_b64_tr_b16 v[194:195], v26 offset:33280
    s_add_u32 m0, s73, 16384
    s_mul_i32 s75, s67, 229376
    s_add_u32 s75, s75, s71
    buffer_load_dwordx4 v16, s[12:15], s75 offen lds
    v_mfma_f32_32x32x16_bf16 v[124:139], a[52:55], v[164:167], v[124:139]
    ds_read_b64_tr_b16 v[196:197], v25 offset:34816
    ds_read_b64_tr_b16 v[198:199], v25 offset:35328
    ds_read_b64_tr_b16 v[200:201], v26 offset:34816
    v_mfma_f32_32x32x16_bf16 v[140:155], a[52:55], v[168:171], v[140:155]
    ds_read_b64_tr_b16 v[202:203], v26 offset:35328
    buffer_load_dwordx4 v17, s[12:15], s75 offen offset:1024 lds
    s_add_u32 s67, s67, 1
    s_cmp_eq_u32 s67, 7
    s_cselect_b32 s67, 0, s67
    v_mfma_f32_32x32x16_bf16 v[124:139], a[56:59], v[172:175], v[124:139]
    ds_read_b64_tr_b16 v[204:205], v25 offset:36864
    ds_read_b64_tr_b16 v[206:207], v25 offset:37376
    ds_read_b64_tr_b16 v[208:209], v26 offset:36864
    v_mfma_f32_32x32x16_bf16 v[140:155], a[56:59], v[176:179], v[140:155]
    ds_read_b64_tr_b16 v[210:211], v26 offset:37376
    ds_read_b64_tr_b16 v[212:213], v25 offset:38912
    ds_read_b64_tr_b16 v[214:215], v25 offset:39424
    s_add_u32 m0, s73, 24576
    s_mul_i32 s75, s67, 229376
    s_add_u32 s75, s75, s71
    buffer_load_dwordx4 v16, s[12:15], s75 offen lds
    v_mfma_f32_32x32x16_bf16 v[124:139], a[60:63], v[180:183], v[124:139]
    ds_read_b64_tr_b16 v[216:217], v26 offset:38912
    ds_read_b64_tr_b16 v[218:219], v26 offset:39424
    v_mfma_f32_32x32x16_bf16 v[140:155], a[60:63], v[184:187], v[140:155]
    buffer_load_dwordx4 v17, s[12:15], s75 offen offset:1024 lds
    s_add_u32 s67, s67, 1
    s_cmp_eq_u32 s67, 7
    s_cselect_b32 s67, 0, s67
    s_waitcnt lgkmcnt(8)
    v_mfma_f32_32x32x16_bf16 v[124:139], a[64:67], v[188:191], v[124:139]
    ds_read_b64_tr_b16 v[156:157], v25 offset:40960
    ds_read_b64_tr_b16 v[158:159], v25 offset:41472
    ds_read_b64_tr_b16 v[160:161], v26 offset:40960
    v_mfma_f32_32x32x16_bf16 v[140:155], a[64:67], v[192:195], v[140:155]
    ds_read_b64_tr_b16 v[162:163], v26 offset:41472
    ds_read_b64_tr_b16 v[164:165], v25 offset:43008
    ds_read_b64_tr_b16 v[166:167], v25 offset:43520
    v_mfma_f32_32x32x16_bf16 v[124:139], a[68:71], v[196:199], v[124:139]
    ds_read_b64_tr_b16 v[168:169], v26 offset:43008
    ds_read_b64_tr_b16 v[170:171], v26 offset:43520
    v_mfma_f32_32x32x16_bf16 v[140:155], a[68:71], v[200:203], v[140:155]
    s_waitcnt lgkmcnt(8)
    v_mfma_f32_32x32x16_bf16 v[124:139], a[72:75], v[204:207], v[124:139]
    ds_read_b64_tr_b16 v[172:173], v25 offset:45056
    ds_read_b64_tr_b16 v[174:175], v25 offset:45568
    ds_read_b64_tr_b16 v[176:177], v26 offset:45056
    v_mfma_f32_32x32x16_bf16 v[140:155], a[72:75], v[208:211], v[140:155]
    ds_read_b64_tr_b16 v[178:179], v26 offset:45568
    ds_read_b64_tr_b16 v[180:181], v25 offset:47104
    ds_read_b64_tr_b16 v[182:183], v25 offset:47616
    s_add_u32 m0, s45, 0
    s_nop 0
    buffer_load_dwordx4 v37, s[20:23], s36 offen offset:0 lds
    v_mfma_f32_32x32x16_bf16 v[124:139], a[76:79], v[212:215], v[124:139]
    ds_read_b64_tr_b16 v[184:185], v26 offset:47104
    ds_read_b64_tr_b16 v[186:187], v26 offset:47616
    v_mfma_f32_32x32x16_bf16 v[140:155], a[76:79], v[216:219], v[140:155]
    buffer_load_dwordx4 v38, s[20:23], s36 offen offset:1024 lds
    s_waitcnt lgkmcnt(8)
    v_mfma_f32_32x32x16_bf16 v[124:139], a[80:83], v[156:159], v[124:139]
    v_mfma_f32_32x32x16_bf16 v[140:155], a[80:83], v[160:163], v[140:155]
    s_waitcnt vmcnt(14) lgkmcnt(0)
    s_barrier
    ds_read_b64_tr_b16 v[188:189], v25 offset:49152
    ds_read_b64_tr_b16 v[190:191], v25 offset:49664
    ds_read_b64_tr_b16 v[192:193], v26 offset:49152
    ds_read_b64_tr_b16 v[194:195], v26 offset:49664
    buffer_load_dwordx4 v39, s[20:23], s36 offen offset:2048 lds
    v_mfma_f32_32x32x16_bf16 v[124:139], a[84:87], v[164:167], v[124:139]
    ds_read_b64_tr_b16 v[196:197], v25 offset:51200
    ds_read_b64_tr_b16 v[198:199], v25 offset:51712
    ds_read_b64_tr_b16 v[200:201], v26 offset:51200
    buffer_load_dwordx4 v40, s[20:23], s36 offen offset:3072 lds
    s_add_u32 s36, s36, 28672
    s_cmp_eq_u32 s36, s38
    s_cselect_b32 s36, s37, s36
    v_mfma_f32_32x32x16_bf16 v[140:155], a[84:87], v[168:171], v[140:155]
    ds_read_b64_tr_b16 v[202:203], v26 offset:51712
    s_add_u32 m0, s45, 4096
    s_nop 0
    buffer_load_dwordx4 v37, s[20:23], s36 offen offset:0 lds
    s_waitcnt vmcnt(12)
    s_mov_b32 s61, 393216
    s_mov_b64 exec, 1
    buffer_store_dword v20, v29, s[28:31], s61 offen sc1
    s_mov_b64 exec, -1
    v_mfma_f32_32x32x16_bf16 v[124:139], a[88:91], v[172:175], v[124:139]
    ds_read_b64_tr_b16 v[204:205], v25 offset:53248
    ds_read_b64_tr_b16 v[206:207], v25 offset:53760
    ds_read_b64_tr_b16 v[208:209], v26 offset:53248
    v_mfma_f32_32x32x16_bf16 v[140:155], a[88:91], v[176:179], v[140:155]
    ds_read_b64_tr_b16 v[210:211], v26 offset:53760
    ds_read_b64_tr_b16 v[212:213], v25 offset:55296
    ds_read_b64_tr_b16 v[214:215], v25 offset:55808
    buffer_load_dwordx4 v38, s[20:23], s36 offen offset:1024 lds
    v_mfma_f32_32x32x16_bf16 v[124:139], a[92:95], v[180:183], v[124:139]
    ds_read_b64_tr_b16 v[216:217], v26 offset:55296
    ds_read_b64_tr_b16 v[218:219], v26 offset:55808
    v_mfma_f32_32x32x16_bf16 v[140:155], a[92:95], v[184:187], v[140:155]
    buffer_load_dwordx4 v39, s[20:23], s36 offen offset:2048 lds
    s_waitcnt lgkmcnt(8)
    v_mfma_f32_32x32x16_bf16 v[124:139], a[96:99], v[188:191], v[124:139]
    v_mfma_f32_32x32x16_bf16 v[140:155], a[96:99], v[192:195], v[140:155]
    s_waitcnt vmcnt(12) lgkmcnt(0)
    s_barrier
    ds_read_b64_tr_b16 v[156:157], v25 offset:0
    ds_read_b64_tr_b16 v[158:159], v25 offset:512
    ds_read_b64_tr_b16 v[160:161], v26 offset:0
    ds_read_b64_tr_b16 v[162:163], v26 offset:512
    buffer_load_dwordx4 v40, s[20:23], s36 offen offset:3072 lds
    s_add_u32 s36, s36, 28672
    s_cmp_eq_u32 s36, s38
    s_cselect_b32 s36, s37, s36
    v_mfma_f32_32x32x16_bf16 v[124:139], a[100:103], v[196:199], v[124:139]
    ds_read_b64_tr_b16 v[164:165], v25 offset:2048
    ds_read_b64_tr_b16 v[166:167], v25 offset:2560
    ds_read_b64_tr_b16 v[168:169], v26 offset:2048
    v_mfma_f32_32x32x16_bf16 v[140:155], a[100:103], v[200:203], v[140:155]
    ds_read_b64_tr_b16 v[170:171], v26 offset:2560
    s_add_u32 m0, s73, 32768
    s_mul_i32 s75, s67, 229376
    s_add_u32 s75, s75, s71
    buffer_load_dwordx4 v16, s[12:15], s75 offen lds
    v_mfma_f32_32x32x16_bf16 v[124:139], a[104:107], v[204:207], v[124:139]
    ds_read_b64_tr_b16 v[172:173], v25 offset:4096
    ds_read_b64_tr_b16 v[174:175], v25 offset:4608
    ds_read_b64_tr_b16 v[176:177], v26 offset:4096
    v_mfma_f32_32x32x16_bf16 v[140:155], a[104:107], v[208:211], v[140:155]
    ds_read_b64_tr_b16 v[178:179], v26 offset:4608
    ds_read_b64_tr_b16 v[180:181], v25 offset:6144
    ds_read_b64_tr_b16 v[182:183], v25 offset:6656
    buffer_load_dwordx4 v17, s[12:15], s75 offen offset:1024 lds
    s_add_u32 s67, s67, 1
    s_cmp_eq_u32 s67, 7
    s_cselect_b32 s67, 0, s67
    v_mfma_f32_32x32x16_bf16 v[124:139], a[108:111], v[212:215], v[124:139]
    ds_read_b64_tr_b16 v[184:185], v26 offset:6144
    ds_read_b64_tr_b16 v[186:187], v26 offset:6656
    v_mfma_f32_32x32x16_bf16 v[140:155], a[108:111], v[216:219], v[140:155]
    s_add_u32 m0, s73, 40960
    s_mul_i32 s75, s67, 229376
    s_add_u32 s75, s75, s71
    buffer_load_dwordx4 v16, s[12:15], s75 offen lds
    s_waitcnt lgkmcnt(8)
    v_mfma_f32_32x32x16_bf16 v[92:107], v[156:159], a[0:3], 0
    ds_read_b64_tr_b16 v[188:189], v25 offset:8192
    ds_read_b64_tr_b16 v[190:191], v25 offset:8704
    ds_read_b64_tr_b16 v[192:193], v26 offset:8192
    s_mul_i32 s63, s60, 86016
    s_lshl_b32 s64, s77, 10
    s_add_u32 s63, s63, s64
    s_add_u32 s63, s63, 1048576
    s_add_u32 s64, s63, 43008
    v_cvt_pk_bf16_f32 v236, v124, v125
    v_cvt_pk_bf16_f32 v237, v126, v127
    v_cvt_pk_bf16_f32 v238, v128, v129
    v_mfma_f32_32x32x16_bf16 v[108:123], v[160:163], a[0:3], 0
    ds_read_b64_tr_b16 v[194:195], v26 offset:8704
    ds_read_b64_tr_b16 v[196:197], v25 offset:10240
    ds_read_b64_tr_b16 v[198:199], v25 offset:10752
    buffer_load_dwordx4 v17, s[12:15], s75 offen offset:1024 lds
    s_add_u32 s67, s67, 1
    s_cmp_eq_u32 s67, 7
    s_cselect_b32 s67, 0, s67
    v_cvt_pk_bf16_f32 v239, v130, v131
    buffer_store_dwordx4 v[236:239], v28, s[28:31], s63 offen offset:0 sc1
    v_cvt_pk_bf16_f32 v240, v132, v133
    v_cvt_pk_bf16_f32 v241, v134, v135
    v_mfma_f32_32x32x16_bf16 v[92:107], v[164:167], a[4:7], v[92:107]
    ds_read_b64_tr_b16 v[200:201], v26 offset:10240
    ds_read_b64_tr_b16 v[202:203], v26 offset:10752
    v_cvt_pk_bf16_f32 v242, v136, v137
    v_cvt_pk_bf16_f32 v243, v138, v139
    buffer_store_dwordx4 v[240:243], v28, s[28:31], s64 offen offset:0 sc1
    v_cvt_pk_bf16_f32 v244, v140, v141
    v_mfma_f32_32x32x16_bf16 v[108:123], v[168:171], a[4:7], v[108:123]
    s_add_u32 m0, s73, 49152
    s_mul_i32 s75, s67, 229376
    s_add_u32 s75, s75, s71
    buffer_load_dwordx4 v16, s[12:15], s75 offen lds
    v_cvt_pk_bf16_f32 v245, v142, v143
    v_cvt_pk_bf16_f32 v246, v144, v145
    v_cvt_pk_bf16_f32 v247, v146, v147
    buffer_store_dwordx4 v[244:247], v28, s[28:31], s63 offen offset:512 sc1
    s_waitcnt lgkmcnt(8)
    v_mfma_f32_32x32x16_bf16 v[92:107], v[172:175], a[8:11], v[92:107]
    ds_read_b64_tr_b16 v[204:205], v25 offset:12288
    ds_read_b64_tr_b16 v[206:207], v25 offset:12800
    ds_read_b64_tr_b16 v[208:209], v26 offset:12288
    v_cvt_pk_bf16_f32 v248, v148, v149
    v_cvt_pk_bf16_f32 v249, v150, v151
    v_cvt_pk_bf16_f32 v250, v152, v153
    v_cvt_pk_bf16_f32 v251, v154, v155
    v_mfma_f32_32x32x16_bf16 v[108:123], v[176:179], a[8:11], v[108:123]
    ds_read_b64_tr_b16 v[210:211], v26 offset:12800
    ds_read_b64_tr_b16 v[212:213], v25 offset:14336
    ds_read_b64_tr_b16 v[214:215], v25 offset:14848
    buffer_load_dwordx4 v17, s[12:15], s75 offen offset:1024 lds
    s_add_u32 s67, s67, 1
    s_cmp_eq_u32 s67, 7
    s_cselect_b32 s67, 0, s67
    buffer_store_dwordx4 v[248:251], v28, s[28:31], s64 offen offset:512 sc1
    v_mfma_f32_32x32x16_bf16 v[92:107], v[180:183], a[12:15], v[92:107]
    ds_read_b64_tr_b16 v[216:217], v26 offset:14336
    ds_read_b64_tr_b16 v[218:219], v26 offset:14848
    v_mfma_f32_32x32x16_bf16 v[108:123], v[184:187], a[12:15], v[108:123]
    s_waitcnt lgkmcnt(8)
    v_mfma_f32_32x32x16_bf16 v[92:107], v[188:191], a[16:19], v[92:107]
    v_mfma_f32_32x32x16_bf16 v[108:123], v[192:195], a[16:19], v[108:123]
    s_waitcnt vmcnt(19) lgkmcnt(0)
    s_barrier
    ds_read_b64_tr_b16 v[156:157], v25 offset:16384
    ds_read_b64_tr_b16 v[158:159], v25 offset:16896
    ds_read_b64_tr_b16 v[160:161], v26 offset:16384
    ds_read_b64_tr_b16 v[162:163], v26 offset:16896
    v_mfma_f32_32x32x16_bf16 v[92:107], v[196:199], a[20:23], v[92:107]
    ds_read_b64_tr_b16 v[164:165], v25 offset:18432
    ds_read_b64_tr_b16 v[166:167], v25 offset:18944
    ds_read_b64_tr_b16 v[168:169], v26 offset:18432
    v_mfma_f32_32x32x16_bf16 v[108:123], v[200:203], a[20:23], v[108:123]
    ds_read_b64_tr_b16 v[170:171], v26 offset:18944
    s_mov_b32 s65, 393216
    s_cmp_eq_u64 s[48:49], 0
    s_cselect_b64 exec, 1, s[48:49]
    buffer_load_dword v58, v55, s[28:31], s65 offen sc1
    s_mov_b64 exec, -1
    v_mfma_f32_32x32x16_bf16 v[92:107], v[204:207], a[24:27], v[92:107]
    ds_read_b64_tr_b16 v[172:173], v25 offset:20480
    ds_read_b64_tr_b16 v[174:175], v25 offset:20992
    ds_read_b64_tr_b16 v[176:177], v26 offset:20480
    v_mfma_f32_32x32x16_bf16 v[108:123], v[208:211], a[24:27], v[108:123]
    ds_read_b64_tr_b16 v[178:179], v26 offset:20992
    ds_read_b64_tr_b16 v[180:181], v25 offset:22528
    ds_read_b64_tr_b16 v[182:183], v25 offset:23040
    v_mfma_f32_32x32x16_bf16 v[92:107], v[212:215], a[28:31], v[92:107]
    ds_read_b64_tr_b16 v[184:185], v26 offset:22528
    ds_read_b64_tr_b16 v[186:187], v26 offset:23040
    v_mfma_f32_32x32x16_bf16 v[108:123], v[216:219], a[28:31], v[108:123]
    s_waitcnt lgkmcnt(8)
    v_mfma_f32_32x32x16_bf16 v[92:107], v[156:159], a[32:35], v[92:107]
    ds_read_b64_tr_b16 v[188:189], v25 offset:24576
    ds_read_b64_tr_b16 v[190:191], v25 offset:25088
    ds_read_b64_tr_b16 v[192:193], v26 offset:24576
    v_mfma_f32_32x32x16_bf16 v[108:123], v[160:163], a[32:35], v[108:123]
    ds_read_b64_tr_b16 v[194:195], v26 offset:25088
    ds_read_b64_tr_b16 v[196:197], v25 offset:26624
    ds_read_b64_tr_b16 v[198:199], v25 offset:27136
    v_mfma_f32_32x32x16_bf16 v[92:107], v[164:167], a[36:39], v[92:107]
    ds_read_b64_tr_b16 v[200:201], v26 offset:26624
    ds_read_b64_tr_b16 v[202:203], v26 offset:27136
    v_mfma_f32_32x32x16_bf16 v[108:123], v[168:171], a[36:39], v[108:123]
    s_waitcnt lgkmcnt(8)
    v_mfma_f32_32x32x16_bf16 v[92:107], v[172:175], a[40:43], v[92:107]
    ds_read_b64_tr_b16 v[204:205], v25 offset:28672
    ds_read_b64_tr_b16 v[206:207], v25 offset:29184
    ds_read_b64_tr_b16 v[208:209], v26 offset:28672
    v_mfma_f32_32x32x16_bf16 v[108:123], v[176:179], a[40:43], v[108:123]
    ds_read_b64_tr_b16 v[210:211], v26 offset:29184
    ds_read_b64_tr_b16 v[212:213], v25 offset:30720
    ds_read_b64_tr_b16 v[214:215], v25 offset:31232
    v_mfma_f32_32x32x16_bf16 v[92:107], v[180:183], a[44:47], v[92:107]
    ds_read_b64_tr_b16 v[216:217], v26 offset:30720
    ds_read_b64_tr_b16 v[218:219], v26 offset:31232
    v_mfma_f32_32x32x16_bf16 v[108:123], v[184:187], a[44:47], v[108:123]
    s_waitcnt lgkmcnt(8)
    v_mfma_f32_32x32x16_bf16 v[92:107], v[188:191], a[48:51], v[92:107]
    v_mfma_f32_32x32x16_bf16 v[108:123], v[192:195], a[48:51], v[108:123]
    s_waitcnt vmcnt(7) lgkmcnt(0)
    s_barrier
    ds_read_b64_tr_b16 v[156:157], v25 offset:32768
    ds_read_b64_tr_b16 v[158:159], v25 offset:33280
    ds_read_b64_tr_b16 v[160:161], v26 offset:32768
    ds_read_b64_tr_b16 v[162:163], v26 offset:33280
    v_mfma_f32_32x32x16_bf16 v[92:107], v[196:199], a[52:55], v[92:107]
    ds_read_b64_tr_b16 v[164:165], v25 offset:34816
    ds_read_b64_tr_b16 v[166:167], v25 offset:35328
    ds_read_b64_tr_b16 v[168:169], v26 offset:34816
    v_mfma_f32_32x32x16_bf16 v[108:123], v[200:203], a[52:55], v[108:123]
    ds_read_b64_tr_b16 v[170:171], v26 offset:35328
    s_waitcnt vmcnt(1)
    s_mov_b32 s61, 393216
    s_mov_b64 exec, 2
    buffer_store_dword v20, v29, s[28:31], s61 offen sc1
    s_mov_b64 exec, -1
    s_waitcnt vmcnt(1)
    v_cmp_ne_u32 vcc, v58, v20
    s_nop 1
    s_and_b64 s[86:87], vcc, s[48:49]
    s_cbranch_scc0 L_pollok_6
    s_mov_b32 s65, 0
    s_mov_b32 s61, 393216
L_poll_5:
    s_mov_b64 exec, s[86:87]
    buffer_load_dword v58, v55, s[28:31], s61 offen sc1
    s_mov_b64 exec, -1
    s_waitcnt vmcnt(0)
    v_cmp_ne_u32 vcc, v58, v20
    s_add_u32 s65, s65, 1
    s_nop 0
    s_and_b64 s[86:87], vcc, s[48:49]
    s_cbranch_scc0 L_pollok_6
    s_cmp_lt_u32 s65, 20000
    s_cbranch_scc1 L_poll_5
L_pollok_6:
    v_mfma_f32_32x32x16_bf16 v[92:107], v[204:207], a[56:59], v[92:107]
    ds_read_b64_tr_b16 v[172:173], v25 offset:36864
    ds_read_b64_tr_b16 v[174:175], v25 offset:37376
    ds_read_b64_tr_b16 v[176:177], v26 offset:36864
    s_mul_i32 s47, s84, 448
    s_add_u32 s47, s47, 1048576
    s_mul_i32 s85, s83, 86016
    s_add_u32 s85, s85, s47
    s_add_u32 m0, s45, 8192
    s_nop 0
    buffer_load_dwordx4 v44, s[28:31], s85 offen offset:0 sc1 lds
    v_mfma_f32_32x32x16_bf16 v[108:123], v[208:211], a[56:59], v[108:123]
    ds_read_b64_tr_b16 v[178:179], v26 offset:37376
    ds_read_b64_tr_b16 v[180:181], v25 offset:38912
    ds_read_b64_tr_b16 v[182:183], v25 offset:39424
    buffer_load_dwordx4 v45, s[28:31], s85 offen offset:1024 sc1 lds
    v_mfma_f32_32x32x16_bf16 v[92:107], v[212:215], a[60:63], v[92:107]
    ds_read_b64_tr_b16 v[184:185], v26 offset:38912
    ds_read_b64_tr_b16 v[186:187], v26 offset:39424
    s_mul_i32 s85, s3, 6144
    s_add_u32 m0, s85, 65536
    s_add_i32 s85, s81, 0
    s_max_i32 s85, s85, 0
    s_mul_i32 s85, s85, 86016
    s_add_u32 s85, s85, s47
    s_add_u32 s85, s85, 7168
    buffer_load_dwordx4 v44, s[28:31], s85 offen offset:0 sc1 lds
    v_mfma_f32_32x32x16_bf16 v[108:123], v[216:219], a[60:63], v[108:123]
    buffer_load_dwordx4 v45, s[28:31], s85 offen offset:1024 sc1 lds
    s_waitcnt lgkmcnt(8)
    v_mfma_f32_32x32x16_bf16 v[92:107], v[156:159], a[64:67], v[92:107]
    ds_read_b64_tr_b16 v[188:189], v25 offset:40960
    ds_read_b64_tr_b16 v[190:191], v25 offset:41472
    ds_read_b64_tr_b16 v[192:193], v26 offset:40960
    v_mfma_f32_32x32x16_bf16 v[108:123], v[160:163], a[64:67], v[108:123]
    ds_read_b64_tr_b16 v[194:195], v26 offset:41472
    ds_read_b64_tr_b16 v[196:197], v25 offset:43008
    ds_read_b64_tr_b16 v[198:199], v25 offset:43520
    s_mul_i32 s85, s3, 6144
    s_add_u32 m0, s85, 67584
    s_add_i32 s85, s81, 1
    s_max_i32 s85, s85, 0
    s_mul_i32 s85, s85, 86016
    s_add_u32 s85, s85, s47
    s_add_u32 s85, s85, 7168
    buffer_load_dwordx4 v44, s[28:31], s85 offen offset:0 sc1 lds
    v_mfma_f32_32x32x16_bf16 v[92:107], v[164:167], a[68:71], v[92:107]
    ds_read_b64_tr_b16 v[200:201], v26 offset:43008
    ds_read_b64_tr_b16 v[202:203], v26 offset:43520
    v_mfma_f32_32x32x16_bf16 v[108:123], v[168:171], a[68:71], v[108:123]
    buffer_load_dwordx4 v45, s[28:31], s85 offen offset:1024 sc1 lds
    s_waitcnt lgkmcnt(8)
    v_mfma_f32_32x32x16_bf16 v[92:107], v[172:175], a[72:75], v[92:107]
    ds_read_b64_tr_b16 v[204:205], v25 offset:45056
    ds_read_b64_tr_b16 v[206:207], v25 offset:45568
    ds_read_b64_tr_b16 v[208:209], v26 offset:45056
    v_mfma_f32_32x32x16_bf16 v[108:123], v[176:179], a[72:75], v[108:123]
    ds_read_b64_tr_b16 v[210:211], v26 offset:45568
    ds_read_b64_tr_b16 v[212:213], v25 offset:47104
    ds_read_b64_tr_b16 v[214:215], v25 offset:47616
    s_mul_i32 s85, s3, 6144
    s_add_u32 m0, s85, 69632
    s_add_i32 s85, s81, 2
    s_max_i32 s85, s85, 0
    s_mul_i32 s85, s85, 86016
    s_add_u32 s85, s85, s47
    s_add_u32 s85, s85, 7168
    buffer_load_dwordx4 v44, s[28:31], s85 offen offset:0 sc1 lds
    v_mfma_f32_32x32x16_bf16 v[92:107], v[180:183], a[76:79], v[92:107]
    ds_read_b64_tr_b16 v[216:217], v26 offset:47104
    ds_read_b64_tr_b16 v[218:219], v26 offset:47616
    v_mfma_f32_32x32x16_bf16 v[108:123], v[184:187], a[76:79], v[108:123]
    buffer_load_dwordx4 v45, s[28:31], s85 offen offset:1024 sc1 lds
    s_waitcnt lgkmcnt(8)
    v_mfma_f32_32x32x16_bf16 v[92:107], v[188:191], a[80:83], v[92:107]
    v_mfma_f32_32x32x16_bf16 v[108:123], v[192:195], a[80:83], v[108:123]
    s_waitcnt lgkmcnt(0)
    s_barrier
    ds_read_b64_tr_b16 v[156:157], v25 offset:49152
    ds_read_b64_tr_b16 v[158:159], v25 offset:49664
    ds_read_b64_tr_b16 v[160:161], v26 offset:49152
    ds_read_b64_tr_b16 v[162:163], v26 offset:49664
    s_add_u32 m0, s44, 0
    s_nop 0
    buffer_load_dwordx4 v37, s[20:23], s36 offen offset:0 lds
    v_mfma_f32_32x32x16_bf16 v[92:107], v[196:199], a[84:87], v[92:107]
    ds_read_b64_tr_b16 v[164:165], v25 offset:51200
    ds_read_b64_tr_b16 v[166:167], v25 offset:51712
    ds_read_b64_tr_b16 v[168:169], v26 offset:51200
    v_mfma_f32_32x32x16_bf16 v[108:123], v[200:203], a[84:87], v[108:123]
    ds_read_b64_tr_b16 v[170:171], v26 offset:51712
    buffer_load_dwordx4 v38, s[20:23], s36 offen offset:1024 lds
    v_mfma_f32_32x32x16_bf16 v[92:107], v[204:207], a[88:91], v[92:107]
    ds_read_b64_tr_b16 v[172:173], v25 offset:53248
    ds_read_b64_tr_b16 v[174:175], v25 offset:53760
    ds_read_b64_tr_b16 v[176:177], v26 offset:53248
    v_mfma_f32_32x32x16_bf16 v[108:123], v[208:211], a[88:91], v[108:123]
    ds_read_b64_tr_b16 v[178:179], v26 offset:53760
    ds_read_b64_tr_b16 v[180:181], v25 offset:55296
    ds_read_b64_tr_b16 v[182:183], v25 offset:55808
    buffer_load_dwordx4 v39, s[20:23], s36 offen offset:2048 lds
    v_mfma_f32_32x32x16_bf16 v[92:107], v[212:215], a[92:95], v[92:107]
    ds_read_b64_tr_b16 v[184:185], v26 offset:55296
    ds_read_b64_tr_b16 v[186:187], v26 offset:55808
    v_mfma_f32_32x32x16_bf16 v[108:123], v[216:219], a[92:95], v[108:123]
    buffer_load_dwordx4 v40, s[20:23], s36 offen offset:3072 lds
    s_add_u32 s36, s36, 28672
    s_cmp_eq_u32 s36, s38
    s_cselect_b32 s36, s37, s36
    s_waitcnt lgkmcnt(8)
    v_mfma_f32_32x32x16_bf16 v[92:107], v[156:159], a[96:99], v[92:107]
    v_mfma_f32_32x32x16_bf16 v[108:123], v[160:163], a[96:99], v[108:123]
    v_mfma_f32_32x32x16_bf16 v[92:107], v[164:167], a[100:103], v[92:107]
    v_mfma_f32_32x32x16_bf16 v[108:123], v[168:171], a[100:103], v[108:123]
    s_waitcnt lgkmcnt(0)
    v_mfma_f32_32x32x16_bf16 v[92:107], v[172:175], a[104:107], v[92:107]
    v_mfma_f32_32x32x16_bf16 v[108:123], v[176:179], a[104:107], v[108:123]
    v_mfma_f32_32x32x16_bf16 v[92:107], v[180:183], a[108:111], v[92:107]
    v_mfma_f32_32x32x16_bf16 v[108:123], v[184:187], a[108:111], v[108:123]
    s_nop 10
    v_cvt_pk_bf16_f32 v220, v92, v93
    v_cvt_pk_bf16_f32 v221, v94, v95
    v_cvt_pk_bf16_f32 v222, v96, v97
    v_cvt_pk_bf16_f32 v223, v98, v99
    v_pk_max_i16 v220, v220, 0
    v_pk_max_i16 v221, v221, 0
    v_pk_max_i16 v222, v222, 0
    v_pk_max_i16 v223, v223, 0
    v_cvt_pk_bf16_f32 v224, v100, v101
    v_cvt_pk_bf16_f32 v225, v102, v103
    v_cvt_pk_bf16_f32 v226, v104, v105
    v_cvt_pk_bf16_f32 v227, v106, v107
    v_pk_max_i16 v224, v224, 0
    v_pk_max_i16 v225, v225, 0
    v_pk_max_i16 v226, v226, 0
    v_pk_max_i16 v227, v227, 0
    v_cvt_pk_bf16_f32 v228, v108, v109
    v_cvt_pk_bf16_f32 v229, v110, v111
    v_cvt_pk_bf16_f32 v230, v112, v113
    v_cvt_pk_bf16_f32 v231, v114, v115
    v_pk_max_i16 v228, v228, 0
    v_pk_max_i16 v229, v229, 0
    v_pk_max_i16 v230, v230, 0
    v_pk_max_i16 v231, v231, 0
    v_cvt_pk_bf16_f32 v232, v116, v117
    v_cvt_pk_bf16_f32 v233, v118, v119
    v_cvt_pk_bf16_f32 v234, v120, v121
    v_cvt_pk_bf16_f32 v235, v122, v123
    v_pk_max_i16 v232, v232, 0
    v_pk_max_i16 v233, v233, 0
    v_pk_max_i16 v234, v234, 0
    v_pk_max_i16 v235, v235, 0
    s_mov_b32 s65, 393216
    s_cmp_eq_u64 s[50:51], 0
    s_cselect_b64 exec, 1, s[50:51]
    buffer_load_dword v58, v55, s[28:31], s65 offen sc1
    s_mov_b64 exec, -1
    s_mul_i32 s63, s60, 114688
    s_lshl_b32 s64, s78, 12
    s_add_u32 s63, s63, s64
    s_add_u32 s63, s63, 7340032
    buffer_store_dwordx4 v[220:223], v32, s[28:31], s63 offen offset:0 sc1
    buffer_store_dwordx4 v[224:227], v32, s[28:31], s63 offen offset:1024 sc1
    buffer_store_dwordx4 v[228:231], v32, s[28:31], s63 offen offset:2048 sc1
    buffer_store_dwordx4 v[232:235], v32, s[28:31], s63 offen offset:3072 sc1
    v_mov_b32 v252, 0x3f803f80
    v_mov_b32 v253, 0x3f803f80
    v_mov_b32 v254, 0x3f803f80
    v_mov_b32 v255, 0x3f803f80
    s_waitcnt vmcnt(9)
L_p2:
    s_cmp_eq_u32 s59, 7
    s_cselect_b32 s22, 0, s22
    s_nop 7
    v_lshrrev_b32 v2, 2, v6
    v_lshlrev_b32 v3, 9, v2
    v_and_b32 v4, 3, v6
    v_lshl_add_u32 v3, v4, 4, v3
    s_mul_i32 s63, s3, 6144
    s_add_u32 s61, s63, 90560
    v_add_u32 v3, s61, v3
    s_mov_b32 exec_hi, 0xffff
    ds_write_b128 v3, v[252:255]
    s_mov_b64 exec, -1
    s_cmp_ge_i32 s81, 0
    s_cbranch_scc1 L_valid
    v_lshlrev_b32 v4, 2, v4
    v_xor_b32 v4, 28, v4
    v_lshlrev_b32 v4, 4, v4
    v_lshl_add_u32 v4, v6, 9, v4
    s_add_u32 s61, s63, 65536
    v_add_u32 v4, s61, v4
    v_add_u32 v2, s81, v2
    v_cmp_gt_i32 vcc, 0, v2
    s_nop 1
    s_and_b64 exec, vcc, 0xfff
    ds_write_b128 v4, v[252:255]
    s_mov_b64 exec, -1
L_valid:
    s_waitcnt lgkmcnt(0)
    s_barrier
    ds_read_b64_tr_b16 v[212:213], v50 offset:0
    ds_read_b64_tr_b16 v[214:215], v51 offset:0
    ds_read_b64_tr_b16 v[216:217], v50 offset:256
    ds_read_b64_tr_b16 v[218:219], v51 offset:256
    ds_read_b64_tr_b16 v[60:61], v48 offset:0
    ds_read_b64_tr_b16 v[62:63], v49 offset:0
    ds_read_b64_tr_b16 v[64:65], v48 offset:256
    ds_read_b64_tr_b16 v[66:67], v49 offset:256
    ds_read_b64_tr_b16 v[124:125], v48 offset:16384
    ds_read_b64_tr_b16 v[126:127], v49 offset:16384
    ds_read_b64_tr_b16 v[128:129], v48 offset:16640
    ds_read_b64_tr_b16 v[130:131], v49 offset:16640
    v_lshlrev_b32 v2, 2, v7
    v_sub_u32 v2, v8, v2
    v_cmp_le_i32 s[4:5], 0, v2
    v_cmp_le_i32 s[6:7], 1, v2
    v_cmp_le_i32 s[8:9], 2, v2
    v_cmp_le_i32 s[10:11], 3, v2
    v_cmp_le_i32 s[12:13], 8, v2
    v_cmp_le_i32 s[14:15], 9, v2
    v_cmp_le_i32 s[16:17], 10, v2
    v_cmp_le_i32 s[18:19], 11, v2
    v_cmp_le_i32 s[66:67], 16, v2
    v_cmp_le_i32 s[68:69], 17, v2
    v_cmp_le_i32 s[70:71], 18, v2
    v_cmp_le_i32 s[72:73], 19, v2
    v_cmp_le_i32 s[74:75], 24, v2
    v_cmp_le_i32 s[76:77], 25, v2
    v_cmp_le_i32 s[88:89], 26, v2
    v_cmp_le_i32 s[96:97], 27, v2
    s_waitcnt lgkmcnt(8)
    v_or_b32 v218, v218, v43
    s_waitcnt lgkmcnt(4)
    v_mfma_f32_32x32x16_bf16 v[132:147], v[60:63], v[212:215], 0
    ds_read_b64_tr_b16 v[68:69], v48 offset:2048
    ds_read_b64_tr_b16 v[70:71], v49 offset:2048
    v_mfma_f32_32x32x16_bf16 v[132:147], v[64:67], v[216:219], v[132:147]
    ds_read_b64_tr_b16 v[72:73], v48 offset:2304
    ds_read_b64_tr_b16 v[74:75], v49 offset:2304
    s_waitcnt lgkmcnt(4)
    v_mfma_f32_32x32x16_bf16 v[180:195], v[124:127], v[212:215], 0
    ds_read_b64_tr_b16 v[76:77], v48 offset:4096
    ds_read_b64_tr_b16 v[78:79], v49 offset:4096
    v_mov_b32 v4, 0xffff
    v_mov_b32 v5, 0xffff0000
    v_cndmask_b32 v10, 0, v4, s[4:5]
    v_cndmask_b32 v3, 0, v5, s[6:7]
    v_or_b32 v10, v10, v3
    v_cndmask_b32 v11, 0, v4, s[8:9]
    v_cndmask_b32 v3, 0, v5, s[10:11]
    v_mfma_f32_32x32x16_bf16 v[180:195], v[128:131], v[216:219], v[180:195]
    ds_read_b64_tr_b16 v[80:81], v48 offset:4352
    ds_read_b64_tr_b16 v[82:83], v49 offset:4352
    v_or_b32 v11, v11, v3
    v_cndmask_b32 v12, 0, v4, s[12:13]
    v_cndmask_b32 v3, 0, v5, s[14:15]
    v_or_b32 v12, v12, v3
    v_cndmask_b32 v13, 0, v4, s[16:17]
    v_cndmask_b32 v3, 0, v5, s[18:19]
    v_or_b32 v13, v13, v3
    s_waitcnt lgkmcnt(4)
    v_mfma_f32_32x32x16_bf16 v[148:163], v[68:71], v[212:215], 0
    ds_read_b64_tr_b16 v[84:85], v48 offset:6144
    s_waitcnt vmcnt(5)
    ds_read_b64_tr_b16 v[86:87], v49 offset:6144
    v_cndmask_b32 v14, 0, v4, s[66:67]
    v_cndmask_b32 v3, 0, v5, s[68:69]
    v_or_b32 v14, v14, v3
    v_cndmask_b32 v15, 0, v4, s[70:71]
    v_cndmask_b32 v3, 0, v5, s[72:73]
    v_or_b32 v15, v15, v3
    v_mfma_f32_32x32x16_bf16 v[148:163], v[72:75], v[216:219], v[148:163]
    ds_read_b64_tr_b16 v[88:89], v48 offset:6400
    ds_read_b64_tr_b16 v[90:91], v49 offset:6400
    v_cndmask_b32 v16, 0, v4, s[74:75]
    v_cndmask_b32 v3, 0, v5, s[76:77]
    v_or_b32 v16, v16, v3
    v_cndmask_b32 v17, 0, v4, s[88:89]
    v_cndmask_b32 v3, 0, v5, s[96:97]
    v_or_b32 v17, v17, v3
    s_waitcnt lgkmcnt(4)
    v_mfma_f32_32x32x16_bf16 v[164:179], v[76:79], v[212:215], 0
    ds_read_b64_tr_b16 v[92:93], v48 offset:8192
    ds_read_b64_tr_b16 v[94:95], v49 offset:8192
    v_cndmask_b32 v180, v132, v180, s[4:5]
    v_cndmask_b32 v181, v133, v181, s[6:7]
    s_waitcnt vmcnt(4)
    v_cmp_ne_u32 vcc, v58, v20
    s_nop 1
    s_and_b64 s[86:87], vcc, s[50:51]
    s_cbranch_scc0 L_pollok_8
    s_mov_b32 s65, 0
    s_mov_b32 s61, 393216
L_poll_7:
    s_mov_b64 exec, s[86:87]
    buffer_load_dword v58, v55, s[28:31], s61 offen sc1
    s_mov_b64 exec, -1
    s_waitcnt vmcnt(0)
    v_cmp_ne_u32 vcc, v58, v20
    s_add_u32 s65, s65, 1
    s_nop 0
    s_and_b64 s[86:87], vcc, s[50:51]
    s_cbranch_scc0 L_pollok_8
    s_cmp_lt_u32 s65, 20000
    s_cbranch_scc1 L_poll_7
L_pollok_8:
    s_mul_i32 s85, s3, 6144
    s_add_u32 m0, s85, 90112
    s_add_i32 s85, s81, 0
    s_max_i32 s85, s85, 0
    s_mul_i32 s85, s85, 86016
    s_add_u32 s85, s85, s47
    s_add_u32 s85, s85, 14336
    s_mov_b32 exec_lo, 0x0fffffff
    s_mov_b32 exec_hi, 0x0fffffff
    buffer_load_dwordx4 v46, s[28:31], s85 offen offset:0 sc1 lds
    s_mov_b64 exec, -1
    v_cndmask_b32 v182, v134, v182, s[8:9]
    s_mov_b32 s65, 393216
    s_cmp_eq_u64 s[52:53], 0
    s_cselect_b64 exec, 1, s[52:53]
    buffer_load_dword v59, v56, s[28:31], s65 offen sc1
    s_mov_b64 exec, -1
    s_mov_b32 exec_lo, 0x0fffffff
    s_mov_b32 exec_hi, 0x0fffffff
    buffer_load_dwordx4 v47, s[28:31], s85 offen offset:1024 sc1 lds
    s_mov_b64 exec, -1
    v_cndmask_b32 v183, v135, v183, s[10:11]
    v_cndmask_b32 v184, v136, v184, s[12:13]
    v_cndmask_b32 v185, v137, v185, s[14:15]
    v_cndmask_b32 v186, v138, v186, s[16:17]
    v_cndmask_b32 v187, v139, v187, s[18:19]
    v_mfma_f32_32x32x16_bf16 v[164:179], v[80:83], v[216:219], v[164:179]
    ds_read_b64_tr_b16 v[96:97], v48 offset:8448
    s_mul_i32 s85, s3, 6144
    s_add_u32 m0, s85, 92160
    s_add_i32 s85, s81, 1
    s_max_i32 s85, s85, 0
    s_mul_i32 s85, s85, 86016
    s_add_u32 s85, s85, s47
    s_add_u32 s85, s85, 14336
    s_mov_b32 exec_lo, 0x0fffffff
    s_mov_b32 exec_hi, 0x0fffffff
    buffer_load_dwordx4 v46, s[28:31], s85 offen offset:0 sc1 lds
    s_mov_b64 exec, -1
    ds_read_b64_tr_b16 v[98:99], v49 offset:8448
    s_mov_b32 exec_lo, 0x0fffffff
    s_mov_b32 exec_hi, 0x0fffffff
    buffer_load_dwordx4 v47, s[28:31], s85 offen offset:1024 sc1 lds
    s_mov_b64 exec, -1
    v_cndmask_b32 v188, v140, v188, s[66:67]
    v_cndmask_b32 v189, v141, v189, s[68:69]
    v_cndmask_b32 v190, v142, v190, s[70:71]
    v_cndmask_b32 v191, v143, v191, s[72:73]
    v_cndmask_b32 v192, v144, v192, s[74:75]
    v_cndmask_b32 v193, v145, v193, s[76:77]
    v_cndmask_b32 v194, v146, v194, s[88:89]
    v_cndmask_b32 v195, v147, v195, s[96:97]
    s_mul_i32 s85, s3, 6144
    s_add_u32 m0, s85, 94208
    s_add_i32 s85, s81, 2
    s_max_i32 s85, s85, 0
    s_mul_i32 s85, s85, 86016
    s_add_u32 s85, s85, s47
    s_add_u32 s85, s85, 14336
    s_mov_b32 exec_lo, 0x0fffffff
    s_mov_b32 exec_hi, 0x0fffffff
    buffer_load_dwordx4 v46, s[28:31], s85 offen offset:0 sc1 lds
    s_mov_b64 exec, -1
    s_waitcnt lgkmcnt(4)
    v_mfma_f32_32x32x16_bf16 v[132:147], v[84:87], v[212:215], 0
    s_mov_b32 exec_lo, 0x0fffffff
    s_mov_b32 exec_hi, 0x0fffffff
    buffer_load_dwordx4 v47, s[28:31], s85 offen offset:1024 sc1 lds
    s_mov_b64 exec, -1
    ds_read_b64_tr_b16 v[100:101], v48 offset:10240
    ds_read_b64_tr_b16 v[102:103], v49 offset:10240
    v_max_f32 v18, v180, v181
    v_max_f32 v19, v182, v183
    v_max3_f32 v18, v184, v185, v18
    v_max3_f32 v19, v186, v187, v19
    v_max3_f32 v18, v188, v189, v18
    v_max3_f32 v19, v190, v191, v19
    s_add_u32 m0, s44, 16384
    s_nop 0
    buffer_load_dwordx4 v37, s[20:23], s36 offen offset:0 lds
    v_max3_f32 v18, v192, v193, v18
    v_max3_f32 v19, v194, v195, v19
    v_mfma_f32_32x32x16_bf16 v[132:147], v[88:91], v[216:219], v[132:147]
    ds_read_b64_tr_b16 v[104:105], v48 offset:10496
    ds_read_b64_tr_b16 v[106:107], v49 offset:10496
    v_max3_f32 v18, v148, v149, v18
    v_max3_f32 v19, v150, v151, v19
    v_max3_f32 v18, v152, v153, v18
    buffer_load_dwordx4 v38, s[20:23], s36 offen offset:1024 lds
    v_max3_f32 v19, v154, v155, v19
    v_max3_f32 v18, v156, v157, v18
    v_max3_f32 v19, v158, v159, v19
    v_max3_f32 v18, v160, v161, v18
    v_max3_f32 v19, v162, v163, v19
    s_waitcnt lgkmcnt(4)
    v_mfma_f32_32x32x16_bf16 v[148:163], v[92:95], v[212:215], 0
    ds_read_b64_tr_b16 v[108:109], v48 offset:12288
    ds_read_b64_tr_b16 v[110:111], v49 offset:12288
    v_max3_f32 v18, v164, v165, v18
    buffer_load_dwordx4 v39, s[20:23], s36 offen offset:2048 lds
    v_max3_f32 v19, v166, v167, v19
    v_max3_f32 v18, v168, v169, v18
    v_max3_f32 v19, v170, v171, v19
    v_mfma_f32_32x32x16_bf16 v[148:163], v[96:99], v[216:219], v[148:163]
    ds_read_b64_tr_b16 v[112:113], v48 offset:12544
    ds_read_b64_tr_b16 v[114:115], v49 offset:12544
    v_max3_f32 v18, v172, v173, v18
    v_max3_f32 v19, v174, v175, v19
    v_max3_f32 v18, v176, v177, v18
    v_max3_f32 v19, v178, v179, v19
    buffer_load_dwordx4 v40, s[20:23], s36 offen offset:3072 lds
    s_mov_b32 s37, s38
    s_add_u32 s38, s37, 229376
    s_mul_i32 s36, s43, 28672
    s_add_u32 s36, s36, s37
    s_waitcnt lgkmcnt(4)
    v_mfma_f32_32x32x16_bf16 v[164:179], v[100:103], v[212:215], 0
    ds_read_b64_tr_b16 v[116:117], v48 offset:14336
    ds_read_b64_tr_b16 v[118:119], v49 offset:14336
    v_max3_f32 v18, v132, v133, v18
    v_max3_f32 v19, v134, v135, v19
    s_add_u32 m0, s44, 32768
    s_nop 0
    buffer_load_dwordx4 v37, s[20:23], s36 offen offset:0 lds
    v_max3_f32 v18, v136, v137, v18
    v_max3_f32 v19, v138, v139, v19
    v_mfma_f32_32x32x16_bf16 v[164:179], v[104:107], v[216:219], v[164:179]
    s_waitcnt vmcnt(10)
    v_cmp_ne_u32 vcc, v59, v20
    s_nop 1
    s_and_b64 s[86:87], vcc, s[52:53]
    s_cbranch_scc0 L_pollok_10
    s_mov_b32 s65, 0
    s_mov_b32 s61, 393216
L_poll_9:
    s_mov_b64 exec, s[86:87]
    buffer_load_dword v59, v56, s[28:31], s61 offen sc1
    s_mov_b64 exec, -1
    s_waitcnt vmcnt(0)
    v_cmp_ne_u32 vcc, v59, v20
    s_add_u32 s65, s65, 1
    s_nop 0
    s_and_b64 s[86:87], vcc, s[52:53]
    s_cbranch_scc0 L_pollok_10
    s_cmp_lt_u32 s65, 20000
    s_cbranch_scc1 L_poll_9
L_pollok_10:
    buffer_load_dwordx4 v38, s[20:23], s36 offen offset:1024 lds
    ds_read_b64_tr_b16 v[120:121], v48 offset:14592
    ds_read_b64_tr_b16 v[122:123], v49 offset:14592
    v_max3_f32 v18, v140, v141, v18
    v_max3_f32 v19, v142, v143, v19
    v_max3_f32 v18, v144, v145, v18
    v_max3_f32 v19, v146, v147, v19
    s_waitcnt lgkmcnt(4)
    v_mfma_f32_32x32x16_bf16 v[132:147], v[108:111], v[212:215], 0
    v_max3_f32 v18, v148, v149, v18
    v_max3_f32 v19, v150, v151, v19
    buffer_load_dwordx4 v39, s[20:23], s36 offen offset:2048 lds
    v_max3_f32 v18, v152, v153, v18
    v_max3_f32 v19, v154, v155, v19
    v_mfma_f32_32x32x16_bf16 v[132:147], v[112:115], v[216:219], v[132:147]
    v_max3_f32 v18, v156, v157, v18
    v_max3_f32 v19, v158, v159, v19
    v_max3_f32 v18, v160, v161, v18
    v_max3_f32 v19, v162, v163, v19
    s_waitcnt lgkmcnt(0)
    v_mfma_f32_32x32x16_bf16 v[148:163], v[116:119], v[212:215], 0
    buffer_load_dwordx4 v40, s[20:23], s36 offen offset:3072 lds
    s_add_u32 s36, s36, 28672
    s_cmp_eq_u32 s36, s38
    s_cselect_b32 s36, s37, s36
    v_max3_f32 v18, v164, v165, v18
    v_max3_f32 v19, v166, v167, v19
    v_max3_f32 v18, v168, v169, v18
    v_max3_f32 v19, v170, v171, v19
    v_mfma_f32_32x32x16_bf16 v[148:163], v[120:123], v[216:219], v[148:163]
    v_max3_f32 v18, v172, v173, v18
    v_max3_f32 v19, v174, v175, v19
    s_add_u32 m0, s44, 49152
    s_nop 0
    buffer_load_dwordx4 v37, s[20:23], s36 offen offset:0 lds
    v_max3_f32 v18, v176, v177, v18
    v_max3_f32 v19, v178, v179, v19
    v_max3_f32 v18, v132, v133, v18
    v_max3_f32 v19, v134, v135, v19
    v_max3_f32 v18, v136, v137, v18
    v_max3_f32 v19, v138, v139, v19
    v_max3_f32 v18, v140, v141, v18
    v_max3_f32 v19, v142, v143, v19
    v_max3_f32 v18, v144, v145, v18
    buffer_load_dwordx4 v38, s[20:23], s36 offen offset:1024 lds
    v_max3_f32 v19, v146, v147, v19
    v_max3_f32 v18, v148, v149, v18
    v_max3_f32 v19, v150, v151, v19
    v_max3_f32 v18, v152, v153, v18
    v_max3_f32 v19, v154, v155, v19
    v_max3_f32 v18, v156, v157, v18
    v_max3_f32 v19, v158, v159, v19
    v_max3_f32 v18, v160, v161, v18
    v_max3_f32 v19, v162, v163, v19
    v_max_f32 v18, v18, v19
    v_mov_b32 v19, v18
    buffer_load_dwordx4 v39, s[20:23], s36 offen offset:2048 lds
    s_nop 0
    v_permlane32_swap_b32 v18, v19
    s_mov_b32 s61, 393216
    s_mov_b64 exec, 12
    buffer_store_dword v20, v29, s[28:31], s61 offen sc1
    s_mov_b64 exec, -1
    v_max_f32 v18, v18, v19
    v_sub_f32 v196, 0, v18
    v_sub_f32 v197, 0, v18
    v_mov_b64 v[198:199], v[196:197]
    buffer_load_dwordx4 v40, s[20:23], s36 offen offset:3072 lds
    s_add_u32 s36, s36, 28672
    s_cmp_eq_u32 s36, s38
    s_cselect_b32 s36, s37, s36
    v_mov_b64 v[200:201], v[196:197]
    v_mov_b64 v[202:203], v[196:197]
    v_mov_b64 v[204:205], v[196:197]
    v_mov_b64 v[206:207], v[196:197]
    v_mov_b64 v[208:209], v[196:197]
    v_mov_b64 v[210:211], v[196:197]
    s_nop 1
    v_mfma_f32_32x32x16_bf16 v[148:163], v[68:71], v[212:215], v[196:211]
    s_add_u32 m0, s45, 8192
    s_nop 0
    buffer_load_dwordx4 v37, s[20:23], s36 offen offset:0 lds
    v_sub_f32 v180, v180, v18
    v_sub_f32 v181, v181, v18
    v_sub_f32 v182, v182, v18
    v_sub_f32 v183, v183, v18
    v_sub_f32 v184, v184, v18
    v_sub_f32 v185, v185, v18
    v_sub_f32 v186, v186, v18
    v_sub_f32 v187, v187, v18
    v_mfma_f32_32x32x16_bf16 v[148:163], v[72:75], v[216:219], v[148:163]
    buffer_load_dwordx4 v38, s[20:23], s36 offen offset:1024 lds
    v_exp_f32 v180, v180
    v_exp_f32 v181, v181
    v_exp_f32 v182, v182
    v_exp_f32 v183, v183
    v_exp_f32 v184, v184
    v_exp_f32 v185, v185
    buffer_load_dwordx4 v39, s[20:23], s36 offen offset:2048 lds
    v_mfma_f32_32x32x16_bf16 v[164:179], v[76:79], v[212:215], v[196:211]
    v_exp_f32 v186, v186
    v_exp_f32 v187, v187
    v_cvt_pk_bf16_f32 v180, v180, v181
    v_cvt_pk_bf16_f32 v181, v182, v183
    v_cvt_pk_bf16_f32 v182, v184, v185
    v_cvt_pk_bf16_f32 v183, v186, v187
    v_bfi_b32 v184, v10, 0, v180
    buffer_load_dwordx4 v40, s[20:23], s36 offen offset:3072 lds
    s_add_u32 s36, s36, 28672
    s_cmp_eq_u32 s36, s38
    s_cselect_b32 s36, s37, s36
    v_and_b32 v180, v10, v180
    v_bfi_b32 v185, v11, 0, v181
    v_and_b32 v181, v11, v181
    v_bfi_b32 v186, v12, 0, v182
    v_and_b32 v182, v12, v182
    v_bfi_b32 v187, v13, 0, v183
    v_and_b32 v183, v13, v183
    v_sub_f32 v188, v188, v18
    buffer_load_dwordx4 a[0:3], v30, s[28:31], s39 offen offset:0 sc1
    v_sub_f32 v189, v189, v18
    v_sub_f32 v190, v190, v18
    v_sub_f32 v191, v191, v18
    v_sub_f32 v192, v192, v18
    v_sub_f32 v193, v193, v18
    v_sub_f32 v194, v194, v18
    v_sub_f32 v195, v195, v18
    v_mfma_f32_32x32x16_bf16 v[164:179], v[80:83], v[216:219], v[164:179]
    v_exp_f32 v188, v188
    buffer_load_dwordx4 a[4:7], v31, s[28:31], s39 offen offset:0 sc1
    v_exp_f32 v189, v189
    v_exp_f32 v190, v190
    v_exp_f32 v191, v191
    v_exp_f32 v192, v192
    v_exp_f32 v193, v193
    v_exp_f32 v194, v194
    buffer_load_dwordx4 a[8:11], v30, s[28:31], s39 offen offset:1024 sc1
    v_exp_f32 v195, v195
    v_cvt_pk_bf16_f32 v188, v188, v189
    v_cvt_pk_bf16_f32 v189, v190, v191
    v_cvt_pk_bf16_f32 v190, v192, v193
    v_cvt_pk_bf16_f32 v191, v194, v195
    v_bfi_b32 v192, v14, 0, v188
    v_and_b32 v188, v14, v188
    v_bfi_b32 v193, v15, 0, v189
    v_and_b32 v189, v15, v189
    v_bfi_b32 v194, v16, 0, v190
    buffer_load_dwordx4 a[12:15], v31, s[28:31], s39 offen offset:1024 sc1
    s_add_u32 s39, s39, 2048
    s_cmp_eq_u32 s39, s41
    s_cselect_b32 s39, s40, s39
    v_and_b32 v190, v16, v190
    v_bfi_b32 v195, v17, 0, v191
    v_and_b32 v191, v17, v191
    v_exp_f32 v148, v148
    v_exp_f32 v149, v149
    v_exp_f32 v150, v150
    buffer_load_dwordx4 a[16:19], v30, s[28:31], s39 offen offset:0 sc1
    v_exp_f32 v151, v151
    v_exp_f32 v152, v152
    v_exp_f32 v153, v153
    v_mfma_f32_32x32x16_bf16 v[132:147], v[84:87], v[212:215], v[196:211]
    v_exp_f32 v154, v154
    v_exp_f32 v155, v155
    buffer_load_dwordx4 a[20:23], v31, s[28:31], s39 offen offset:0 sc1
    v_cvt_pk_bf16_f32 v68, v148, v149
    v_cvt_pk_bf16_f32 v69, v150, v151
    v_cvt_pk_bf16_f32 v70, v152, v153
    v_cvt_pk_bf16_f32 v71, v154, v155
    v_exp_f32 v156, v156
    v_exp_f32 v157, v157
    v_exp_f32 v158, v158
    v_exp_f32 v159, v159
    buffer_load_dwordx4 a[24:27], v30, s[28:31], s39 offen offset:1024 sc1
    v_exp_f32 v160, v160
    v_exp_f32 v161, v161
    v_mfma_f32_32x32x16_bf16 v[132:147], v[88:91], v[216:219], v[132:147]
    v_exp_f32 v162, v162
    v_exp_f32 v163, v163
    v_cvt_pk_bf16_f32 v72, v156, v157
    buffer_load_dwordx4 a[28:31], v31, s[28:31], s39 offen offset:1024 sc1
    s_add_u32 s39, s39, 2048
    s_cmp_eq_u32 s39, s41
    s_cselect_b32 s39, s40, s39
    v_cvt_pk_bf16_f32 v73, v158, v159
    v_cvt_pk_bf16_f32 v74, v160, v161
    v_cvt_pk_bf16_f32 v75, v162, v163
    v_exp_f32 v164, v164
    v_exp_f32 v165, v165
    v_exp_f32 v166, v166
    buffer_load_dwordx4 a[32:35], v30, s[28:31], s39 offen offset:0 sc1
    v_exp_f32 v167, v167
    v_exp_f32 v168, v168
    v_exp_f32 v169, v169
    v_mfma_f32_32x32x16_bf16 v[148:163], v[92:95], v[212:215], v[196:211]
    v_exp_f32 v170, v170
    v_exp_f32 v171, v171
    buffer_load_dwordx4 a[36:39], v31, s[28:31], s39 offen offset:0 sc1
    v_cvt_pk_bf16_f32 v76, v164, v165
    v_cvt_pk_bf16_f32 v77, v166, v167
    v_cvt_pk_bf16_f32 v78, v168, v169
    v_cvt_pk_bf16_f32 v79, v170, v171
    v_exp_f32 v172, v172
    v_exp_f32 v173, v173
    v_exp_f32 v174, v174
    v_exp_f32 v175, v175
    buffer_load_dwordx4 a[40:43], v30, s[28:31], s39 offen offset:1024 sc1
    v_exp_f32 v176, v176
    v_exp_f32 v177, v177
    v_mfma_f32_32x32x16_bf16 v[148:163], v[96:99], v[216:219], v[148:163]
    v_exp_f32 v178, v178
    v_exp_f32 v179, v179
    v_cvt_pk_bf16_f32 v80, v172, v173
    buffer_load_dwordx4 a[44:47], v31, s[28:31], s39 offen offset:1024 sc1
    s_add_u32 s39, s39, 2048
    s_cmp_eq_u32 s39, s41
    s_cselect_b32 s39, s40, s39
    v_cvt_pk_bf16_f32 v81, v174, v175
    v_cvt_pk_bf16_f32 v82, v176, v177
    v_cvt_pk_bf16_f32 v83, v178, v179
    v_exp_f32 v132, v132
    v_exp_f32 v133, v133
    v_exp_f32 v134, v134
    buffer_load_dwordx4 a[48:51], v30, s[28:31], s39 offen offset:0 sc1
    v_exp_f32 v135, v135
    v_exp_f32 v136, v136
    v_exp_f32 v137, v137
    v_mfma_f32_32x32x16_bf16 v[164:179], v[100:103], v[212:215], v[196:211]
    v_exp_f32 v138, v138
    v_exp_f32 v139, v139
    buffer_load_dwordx4 a[52:55], v31, s[28:31], s39 offen offset:0 sc1
    s_waitcnt vmcnt(31)
    s_barrier
    ds_read_b128 a[224:227], v52 offset:40960
    ds_read_b128 a[228:231], v52 offset:41984
    ds_read_b128 a[232:235], v52 offset:24576
    ds_read_b128 a[236:239], v52 offset:25600
    ds_read_b128 a[240:243], v52 offset:26624
    ds_read_b128 a[244:247], v52 offset:27648
    ds_read_b128 a[248:251], v52 offset:28672
    ds_read_b128 a[252:255], v52 offset:29696
    v_cvt_pk_bf16_f32 v84, v132, v133
    buffer_load_dwordx4 a[56:59], v30, s[28:31], s39 offen offset:1024 sc1
    v_cvt_pk_bf16_f32 v85, v134, v135
    v_cvt_pk_bf16_f32 v86, v136, v137
    v_cvt_pk_bf16_f32 v87, v138, v139
    v_exp_f32 v140, v140
    v_exp_f32 v141, v141
    s_waitcnt lgkmcnt(6)
    v_mfma_f32_32x32x16_bf16 v[220:235], a[224:227], v[180:183], 0
    v_exp_f32 v142, v142
    buffer_load_dwordx4 a[60:63], v31, s[28:31], s39 offen offset:1024 sc1
    s_mov_b32 s40, s41
    s_add_u32 s41, s40, 16384
    s_lshl_b32 s39, s43, 11
    s_add_u32 s39, s39, s40
    v_exp_f32 v143, v143
    s_waitcnt lgkmcnt(4)
    v_mfma_f32_32x32x16_bf16 v[220:235], a[232:235], v[184:187], v[220:235]
    v_exp_f32 v144, v144
    ds_read_b64_tr_b16 a[160:161], v35 offset:0
    ds_read_b64_tr_b16 a[162:163], v35 offset:1024
    ds_read_b64_tr_b16 a[164:165], v36 offset:0
    ds_read_b64_tr_b16 a[166:167], v36 offset:1024
    ds_read_b64_tr_b16 a[168:169], v35 offset:2048
    ds_read_b64_tr_b16 a[170:171], v35 offset:3072
    ds_read_b64_tr_b16 a[172:173], v36 offset:2048
    ds_read_b64_tr_b16 a[174:175], v36 offset:3072
    v_exp_f32 v145, v145
    v_mfma_f32_32x32x16_bf16 v[164:179], v[104:107], v[216:219], v[164:179]
    v_exp_f32 v146, v146
    ds_read_b64_tr_b16 a[176:177], v35 offset:4096
    ds_read_b64_tr_b16 a[178:179], v35 offset:5120
    ds_read_b64_tr_b16 a[180:181], v36 offset:4096
    ds_read_b64_tr_b16 a[182:183], v36 offset:5120
    ds_read_b64_tr_b16 a[184:185], v35 offset:6144
    ds_read_b64_tr_b16 a[186:187], v35 offset:7168
    ds_read_b64_tr_b16 a[188:189], v36 offset:6144
    ds_read_b64_tr_b16 a[190:191], v36 offset:7168
    v_exp_f32 v147, v147
    v_mfma_f32_32x32x16_bf16 v[220:235], a[228:231], v[188:191], v[220:235]
    ds_read_b128 a[224:227], v52 offset:30720
    ds_read_b64_tr_b16 a[192:193], v33 offset:0
    ds_read_b64_tr_b16 a[194:195], v33 offset:1024
    ds_read_b64_tr_b16 a[196:197], v34 offset:0
    ds_read_b64_tr_b16 a[198:199], v34 offset:1024
    ds_read_b64_tr_b16 a[200:201], v33 offset:2048
    ds_read_b64_tr_b16 a[202:203], v33 offset:3072
    ds_read_b64_tr_b16 a[204:205], v34 offset:2048
    ds_read_b64_tr_b16 a[206:207], v34 offset:3072
    ds_read_b128 a[228:231], v52 offset:31744
    s_mov_b32 s65, 393216
    s_cmp_eq_u64 s[94:95], 0
    s_cselect_b64 exec, 1, s[94:95]
    buffer_load_dword v59, v56, s[28:31], s65 offen sc1
    s_mov_b64 exec, -1
    s_waitcnt vmcnt(30)
    ds_read_b64_tr_b16 a[208:209], v33 offset:16384
    ds_read_b64_tr_b16 a[210:211], v33 offset:17408
    ds_read_b64_tr_b16 a[212:213], v34 offset:16384
    ds_read_b64_tr_b16 a[214:215], v34 offset:17408
    ds_read_b64_tr_b16 a[216:217], v33 offset:18432
    ds_read_b64_tr_b16 a[218:219], v33 offset:19456
    ds_read_b64_tr_b16 a[220:221], v34 offset:18432
    ds_read_b64_tr_b16 a[222:223], v34 offset:19456
    v_cvt_pk_bf16_f32 v88, v140, v141
    v_cvt_pk_bf16_f32 v89, v142, v143
    v_cvt_pk_bf16_f32 v90, v144, v145
    v_cvt_pk_bf16_f32 v91, v146, v147
    s_waitcnt lgkmcnt(15)
    s_add_u32 m0, s45, 0
    s_nop 0
    buffer_load_dwordx4 v37, s[20:23], s36 offen offset:0 lds
    v_exp_f32 v148, v148
    v_exp_f32 v149, v149
    v_mfma_f32_32x32x16_bf16 v[220:235], a[236:239], v[192:195], v[220:235]
    ds_read_b128 a[232:235], v52 offset:32768
    ds_read_b128 a[236:239], v52 offset:33792
    buffer_load_dwordx4 v38, s[20:23], s36 offen offset:1024 lds
    v_exp_f32 v150, v150
    v_exp_f32 v151, v151
    v_mfma_f32_32x32x16_bf16 v[220:235], a[240:243], v[68:71], v[220:235]
    v_exp_f32 v152, v152
    v_exp_f32 v153, v153
    v_mfma_f32_32x32x16_bf16 v[132:147], v[108:111], v[212:215], v[196:211]
    buffer_load_dwordx4 v39, s[20:23], s36 offen offset:2048 lds
    v_exp_f32 v154, v154
    v_exp_f32 v155, v155
    v_mfma_f32_32x32x16_bf16 v[220:235], a[244:247], v[72:75], v[220:235]
    ds_read_b128 a[240:243], v52 offset:34816
    ds_read_b128 a[244:247], v52 offset:35840
    v_cvt_pk_bf16_f32 v92, v148, v149
    v_cvt_pk_bf16_f32 v93, v150, v151
    v_cvt_pk_bf16_f32 v94, v152, v153
    buffer_load_dwordx4 v40, s[20:23], s36 offen offset:3072 lds
    s_add_u32 s36, s36, 28672
    s_cmp_eq_u32 s36, s38
    s_cselect_b32 s36, s37, s36
    v_cvt_pk_bf16_f32 v95, v154, v155
    v_exp_f32 v156, v156
    v_exp_f32 v157, v157
    v_mfma_f32_32x32x16_bf16 v[220:235], a[248:251], v[76:79], v[220:235]
    v_exp_f32 v158, v158
    s_add_u32 m0, s45, 4096
    s_nop 0
    buffer_load_dwordx4 v37, s[20:23], s36 offen offset:0 lds
    v_exp_f32 v159, v159
    v_mfma_f32_32x32x16_bf16 v[220:235], a[252:255], v[80:83], v[220:235]
    ds_read_b128 a[248:251], v52 offset:36864
    ds_read_b128 a[252:255], v52 offset:37888
    v_exp_f32 v160, v160
    v_exp_f32 v161, v161
    buffer_load_dwordx4 v38, s[20:23], s36 offen offset:1024 lds
    v_mfma_f32_32x32x16_bf16 v[132:147], v[112:115], v[216:219], v[132:147]
    v_exp_f32 v162, v162
    v_exp_f32 v163, v163
    s_waitcnt lgkmcnt(14)
    v_mfma_f32_32x32x16_bf16 v[220:235], a[224:227], v[84:87], v[220:235]
    v_cvt_pk_bf16_f32 v96, v156, v157
    buffer_load_dwordx4 v39, s[20:23], s36 offen offset:2048 lds
    v_cvt_pk_bf16_f32 v97, v158, v159
    v_cvt_pk_bf16_f32 v98, v160, v161
    v_cvt_pk_bf16_f32 v99, v162, v163
    v_exp_f32 v164, v164
    v_exp_f32 v165, v165
    v_mfma_f32_32x32x16_bf16 v[220:235], a[228:231], v[88:91], v[220:235]
    ds_read_b128 a[224:227], v52 offset:38912
    ds_read_b128 a[228:231], v52 offset:39936
    buffer_load_dwordx4 v40, s[20:23], s36 offen offset:3072 lds
    s_add_u32 s36, s36, 28672
    s_cmp_eq_u32 s36, s38
    s_cselect_b32 s36, s37, s36
    v_exp_f32 v166, v166
    v_exp_f32 v167, v167
    s_waitcnt lgkmcnt(6)
    v_mfma_f32_32x32x16_bf16 v[220:235], a[232:235], v[92:95], v[220:235]
    v_exp_f32 v168, v168
    s_add_u32 m0, s44, 0
    s_nop 0
    buffer_load_dwordx4 v37, s[20:23], s36 offen offset:0 lds
    v_exp_f32 v169, v169
    v_mfma_f32_32x32x16_bf16 v[148:163], v[116:119], v[212:215], v[196:211]
    v_exp_f32 v170, v170
    v_exp_f32 v171, v171
    v_cvt_pk_bf16_f32 v100, v164, v165
    buffer_load_dwordx4 v38, s[20:23], s36 offen offset:1024 lds
    v_cvt_pk_bf16_f32 v101, v166, v167
    s_waitcnt vmcnt(10)
    v_cmp_ne_u32 vcc, v59, v20
    s_nop 1
    s_and_b64 s[86:87], vcc, s[94:95]
    s_cbranch_scc0 L_pollok_12
    s_mov_b32 s65, 0
    s_mov_b32 s61, 393216
L_poll_11:
    s_mov_b64 exec, s[86:87]
    buffer_load_dword v59, v56, s[28:31], s61 offen sc1
    s_mov_b64 exec, -1
    s_waitcnt vmcnt(0)
    v_cmp_ne_u32 vcc, v59, v20
    s_add_u32 s65, s65, 1
    s_nop 0
    s_and_b64 s[86:87], vcc, s[94:95]
    s_cbranch_scc0 L_pollok_12
    s_cmp_lt_u32 s65, 20000
    s_cbranch_scc1 L_poll_11
L_pollok_12:
    v_cvt_pk_bf16_f32 v102, v168, v169
    v_cvt_pk_bf16_f32 v103, v170, v171
    v_exp_f32 v172, v172
    v_exp_f32 v173, v173
    buffer_load_dwordx4 a[64:67], v30, s[28:31], s39 offen offset:0 sc1
    v_mfma_f32_32x32x16_bf16 v[220:235], a[236:239], v[96:99], v[220:235]
    v_exp_f32 v174, v174
    v_exp_f32 v175, v175
    v_exp_f32 v176, v176
    v_exp_f32 v177, v177
    v_mfma_f32_32x32x16_bf16 v[148:163], v[120:123], v[216:219], v[148:163]
    buffer_load_dwordx4 a[68:71], v31, s[28:31], s39 offen offset:0 sc1
    v_exp_f32 v178, v178
    v_exp_f32 v179, v179
    v_cvt_pk_bf16_f32 v104, v172, v173
    v_cvt_pk_bf16_f32 v105, v174, v175
    v_cvt_pk_bf16_f32 v106, v176, v177
    v_cvt_pk_bf16_f32 v107, v178, v179
    v_exp_f32 v132, v132
    v_exp_f32 v133, v133
    buffer_load_dwordx4 a[72:75], v30, s[28:31], s39 offen offset:1024 sc1
    s_waitcnt lgkmcnt(4)
    v_mfma_f32_32x32x16_bf16 v[220:235], a[240:243], v[100:103], v[220:235]
    v_exp_f32 v134, v134
    v_exp_f32 v135, v135
    v_exp_f32 v136, v136
    v_exp_f32 v137, v137
    buffer_load_dwordx4 a[76:79], v31, s[28:31], s39 offen offset:1024 sc1
    s_add_u32 s39, s39, 2048
    s_cmp_eq_u32 s39, s41
    s_cselect_b32 s39, s40, s39
    v_mfma_f32_32x32x16_bf16 v[220:235], a[244:247], v[104:107], v[220:235]
    v_exp_f32 v138, v138
    v_exp_f32 v139, v139
    v_cvt_pk_bf16_f32 v108, v132, v133
    v_cvt_pk_bf16_f32 v109, v134, v135
    buffer_load_dwordx4 a[80:83], v30, s[28:31], s39 offen offset:0 sc1
    v_cvt_pk_bf16_f32 v110, v136, v137
    v_cvt_pk_bf16_f32 v111, v138, v139
    v_exp_f32 v140, v140
    v_exp_f32 v141, v141
    s_waitcnt lgkmcnt(2)
    v_mfma_f32_32x32x16_bf16 v[220:235], a[248:251], v[108:111], v[220:235]
    v_exp_f32 v142, v142
    buffer_load_dwordx4 a[84:87], v31, s[28:31], s39 offen offset:0 sc1
    v_exp_f32 v143, v143
    v_exp_f32 v144, v144
    v_exp_f32 v145, v145
    v_exp_f32 v146, v146
    v_exp_f32 v147, v147
    v_cvt_pk_bf16_f32 v112, v140, v141
    buffer_load_dwordx4 a[88:91], v30, s[28:31], s39 offen offset:1024 sc1
    v_cvt_pk_bf16_f32 v113, v142, v143
    v_cvt_pk_bf16_f32 v114, v144, v145
    v_cvt_pk_bf16_f32 v115, v146, v147
    v_exp_f32 v148, v148
    v_exp_f32 v149, v149
    v_mfma_f32_32x32x16_bf16 v[220:235], a[252:255], v[112:115], v[220:235]
    v_exp_f32 v150, v150
    buffer_load_dwordx4 a[92:95], v31, s[28:31], s39 offen offset:1024 sc1
    s_add_u32 s39, s39, 2048
    s_cmp_eq_u32 s39, s41
    s_cselect_b32 s39, s40, s39
    v_exp_f32 v151, v151
    v_exp_f32 v152, v152
    v_exp_f32 v153, v153
    v_exp_f32 v154, v154
    buffer_load_dwordx4 a[96:99], v30, s[28:31], s39 offen offset:0 sc1
    v_exp_f32 v155, v155
    v_cvt_pk_bf16_f32 v116, v148, v149
    v_cvt_pk_bf16_f32 v117, v150, v151
    v_cvt_pk_bf16_f32 v118, v152, v153
    v_cvt_pk_bf16_f32 v119, v154, v155
    v_exp_f32 v156, v156
    v_exp_f32 v157, v157
    s_waitcnt lgkmcnt(0)
    v_mfma_f32_32x32x16_bf16 v[220:235], a[224:227], v[116:119], v[220:235]
    buffer_load_dwordx4 a[100:103], v31, s[28:31], s39 offen offset:0 sc1
    v_exp_f32 v158, v158
    v_exp_f32 v159, v159
    v_exp_f32 v160, v160
    v_exp_f32 v161, v161
    v_exp_f32 v162, v162
    v_exp_f32 v163, v163
    buffer_load_dwordx4 a[104:107], v30, s[28:31], s39 offen offset:1024 sc1
    v_cvt_pk_bf16_f32 v120, v156, v157
    v_cvt_pk_bf16_f32 v121, v158, v159
    v_cvt_pk_bf16_f32 v122, v160, v161
    v_cvt_pk_bf16_f32 v123, v162, v163
    s_nop 1
    v_mfma_f32_32x32x16_bf16 v[220:235], a[228:231], v[120:123], v[220:235]
    s_lshl_b32 s63, s83, 15
    s_lshl_b32 s64, s84, 11
    s_add_u32 s63, s63, s64
    s_add_u32 s63, s63, 14680064
    v_cmp_eq_u32 vcc, 0, v7
    s_nop 6
    v_mov_b32 v18, v232
    v_mov_b32 v19, v232
    s_nop 1
    v_permlane32_swap_b32 v18, v19
    v_rcp_f32 v19, v19
    s_nop 0
    v_cndmask_b32 v18, 0, v19, vcc
    v_mul_f32 v220, v220, v19
    v_mul_f32 v221, v221, v19
    v_mul_f32 v222, v222, v19
    v_mul_f32 v223, v223, v19
    v_mul_f32 v224, v224, v19
    v_mul_f32 v225, v225, v19
    v_mul_f32 v226, v226, v19
    v_mul_f32 v227, v227, v19
    v_cvt_pk_bf16_f32 v212, v220, v221
    v_cvt_pk_bf16_f32 v213, v222, v223
    v_cvt_pk_bf16_f32 v214, v224, v225
    v_cvt_pk_bf16_f32 v215, v226, v227
    buffer_store_dwordx4 v[212:215], v32, s[28:31], s63 offen offset:0 sc1
    v_mul_f32 v228, v228, v19
    v_mul_f32 v229, v229, v19
    v_mul_f32 v230, v230, v19
    v_mul_f32 v231, v231, v19
    v_mul_f32 v232, v232, v18
    v_mul_f32 v233, v233, v18
    v_mul_f32 v234, v234, v18
    v_mul_f32 v235, v235, v18
    v_cvt_pk_bf16_f32 v216, v228, v229
    v_cvt_pk_bf16_f32 v217, v230, v231
    v_cvt_pk_bf16_f32 v218, v232, v233
    v_cvt_pk_bf16_f32 v219, v234, v235
    buffer_store_dwordx4 v[216:219], v32, s[28:31], s63 offen offset:1024 sc1
    s_cmp_eq_u32 s59, 7
    s_cbranch_scc1 L_idle
    v_mfma_f32_32x32x16_bf16 v[60:75], a[160:163], a[0:3], 0
    v_mfma_f32_32x32x16_bf16 v[76:91], a[160:163], a[4:7], 0
    buffer_load_dwordx4 a[108:111], v31, s[28:31], s39 offen offset:1024 sc1
    s_add_u32 s39, s39, 2048
    s_cmp_eq_u32 s39, s41
    s_cselect_b32 s39, s40, s39
    v_mfma_f32_32x32x16_bf16 v[92:107], a[164:167], a[0:3], 0
    v_mfma_f32_32x32x16_bf16 v[108:123], a[164:167], a[4:7], 0
    buffer_load_dwordx4 a[112:115], v30, s[28:31], s39 offen offset:0 sc1
    v_mfma_f32_32x32x16_bf16 v[60:75], a[168:171], a[8:11], v[60:75]
    v_mfma_f32_32x32x16_bf16 v[76:91], a[168:171], a[12:15], v[76:91]
    buffer_load_dwordx4 a[116:119], v31, s[28:31], s39 offen offset:0 sc1
    v_mfma_f32_32x32x16_bf16 v[92:107], a[172:175], a[8:11], v[92:107]
    buffer_load_dwordx4 a[120:123], v30, s[28:31], s39 offen offset:1024 sc1
    v_mfma_f32_32x32x16_bf16 v[108:123], a[172:175], a[12:15], v[108:123]
    v_mfma_f32_32x32x16_bf16 v[60:75], a[176:179], a[16:19], v[60:75]
    buffer_load_dwordx4 a[124:127], v31, s[28:31], s39 offen offset:1024 sc1
    s_add_u32 s39, s39, 2048
    s_cmp_eq_u32 s39, s41
    s_cselect_b32 s39, s40, s39
    v_mfma_f32_32x32x16_bf16 v[76:91], a[176:179], a[20:23], v[76:91]
    v_mfma_f32_32x32x16_bf16 v[92:107], a[180:183], a[16:19], v[92:107]
    buffer_load_dwordx4 a[128:131], v30, s[28:31], s39 offen offset:0 sc1
    v_mfma_f32_32x32x16_bf16 v[108:123], a[180:183], a[20:23], v[108:123]
    buffer_load_dwordx4 a[132:135], v31, s[28:31], s39 offen offset:0 sc1
    v_mfma_f32_32x32x16_bf16 v[60:75], a[184:187], a[24:27], v[60:75]
    v_mfma_f32_32x32x16_bf16 v[76:91], a[184:187], a[28:31], v[76:91]
    buffer_load_dwordx4 a[136:139], v30, s[28:31], s39 offen offset:1024 sc1
    v_mfma_f32_32x32x16_bf16 v[92:107], a[188:191], a[24:27], v[92:107]
    v_mfma_f32_32x32x16_bf16 v[108:123], a[188:191], a[28:31], v[108:123]
    buffer_load_dwordx4 a[140:143], v31, s[28:31], s39 offen offset:1024 sc1
    s_add_u32 s39, s39, 2048
    s_cmp_eq_u32 s39, s41
    s_cselect_b32 s39, s40, s39
    v_mfma_f32_32x32x16_bf16 v[60:75], a[192:195], a[32:35], v[60:75]
    buffer_load_dwordx4 v39, s[20:23], s36 offen offset:2048 lds
    v_mfma_f32_32x32x16_bf16 v[76:91], a[192:195], a[36:39], v[76:91]
    v_mfma_f32_32x32x16_bf16 v[92:107], a[196:199], a[32:35], v[92:107]
    buffer_load_dwordx4 v40, s[20:23], s36 offen offset:3072 lds
    s_add_u32 s36, s36, 28672
    s_cmp_eq_u32 s36, s38
    s_cselect_b32 s36, s37, s36
    v_mfma_f32_32x32x16_bf16 v[108:123], a[196:199], a[36:39], v[108:123]
    v_mfma_f32_32x32x16_bf16 v[60:75], a[200:203], a[40:43], v[60:75]
    buffer_load_dwordx4 a[144:147], v30, s[28:31], s39 offen offset:0 sc1
    v_mfma_f32_32x32x16_bf16 v[76:91], a[200:203], a[44:47], v[76:91]
    buffer_load_dwordx4 a[148:151], v31, s[28:31], s39 offen offset:0 sc1
    v_mfma_f32_32x32x16_bf16 v[92:107], a[204:207], a[40:43], v[92:107]
    v_mfma_f32_32x32x16_bf16 v[108:123], a[204:207], a[44:47], v[108:123]
    s_add_u32 m0, s44, 16384
    s_nop 0
    buffer_load_dwordx4 v37, s[20:23], s36 offen offset:0 lds
    v_mfma_f32_32x32x16_bf16 v[60:75], a[208:211], a[48:51], v[60:75]
    v_mfma_f32_32x32x16_bf16 v[76:91], a[208:211], a[52:55], v[76:91]
    ds_read_b64_tr_b16 v[148:149], v33 offset:32768
    ds_read_b64_tr_b16 v[150:151], v33 offset:33792
    buffer_load_dwordx4 v38, s[20:23], s36 offen offset:1024 lds
    v_mfma_f32_32x32x16_bf16 v[92:107], a[212:215], a[48:51], v[92:107]
    ds_read_b64_tr_b16 v[152:153], v34 offset:32768
    ds_read_b64_tr_b16 v[154:155], v34 offset:33792
    buffer_load_dwordx4 a[152:155], v30, s[28:31], s39 offen offset:1024 sc1
    v_mfma_f32_32x32x16_bf16 v[108:123], a[212:215], a[52:55], v[108:123]
    s_mov_b32 s65, 393216
    s_cmp_eq_u64 s[54:55], 0
    s_cselect_b64 exec, 1, s[54:55]
    buffer_load_dword v59, v56, s[28:31], s65 offen sc1
    s_mov_b64 exec, -1
    v_mfma_f32_32x32x16_bf16 v[60:75], a[216:219], a[56:59], v[60:75]
    buffer_load_dwordx4 a[156:159], v31, s[28:31], s39 offen offset:1024 sc1
    s_add_u32 s39, s39, 2048
    s_cmp_eq_u32 s39, s41
    s_cselect_b32 s39, s40, s39
    v_mfma_f32_32x32x16_bf16 v[76:91], a[216:219], a[60:63], v[76:91]
    ds_read_b64_tr_b16 v[156:157], v33 offset:34816
    ds_read_b64_tr_b16 v[158:159], v33 offset:35840
    v_mfma_f32_32x32x16_bf16 v[92:107], a[220:223], a[56:59], v[92:107]
    ds_read_b64_tr_b16 v[160:161], v34 offset:34816
    ds_read_b64_tr_b16 v[162:163], v34 offset:35840
    buffer_load_dwordx4 v39, s[20:23], s36 offen offset:2048 lds
    v_mfma_f32_32x32x16_bf16 v[108:123], a[220:223], a[60:63], v[108:123]
    buffer_load_dwordx4 v40, s[20:23], s36 offen offset:3072 lds
    s_add_u32 s36, s36, 28672
    s_cmp_eq_u32 s36, s38
    s_cselect_b32 s36, s37, s36
    s_waitcnt vmcnt(20)
    s_mov_b32 s61, 393216
    s_mov_b64 exec, 16
    buffer_store_dword v20, v29, s[28:31], s61 offen sc1
    s_mov_b64 exec, -1
    s_waitcnt lgkmcnt(4)
    v_mfma_f32_32x32x16_bf16 v[60:75], v[148:151], a[64:67], v[60:75]
    v_mfma_f32_32x32x16_bf16 v[76:91], v[148:151], a[68:71], v[76:91]
    ds_read_b64_tr_b16 v[124:125], v33 offset:49152
    ds_read_b64_tr_b16 v[126:127], v33 offset:50176
    buffer_load_dwordx4 a[160:163], v30, s[28:31], s39 offen offset:0 sc1
    v_mfma_f32_32x32x16_bf16 v[92:107], v[152:155], a[64:67], v[92:107]
    ds_read_b64_tr_b16 v[128:129], v34 offset:49152
    ds_read_b64_tr_b16 v[130:131], v34 offset:50176
    v_mfma_f32_32x32x16_bf16 v[108:123], v[152:155], a[68:71], v[108:123]
    buffer_load_dwordx4 a[164:167], v31, s[28:31], s39 offen offset:0 sc1
    s_barrier
    s_waitcnt lgkmcnt(4)
    v_mfma_f32_32x32x16_bf16 v[60:75], v[156:159], a[72:75], v[60:75]
    s_add_u32 m0, s44, 32768
    s_nop 0
    buffer_load_dwordx4 v37, s[20:23], s36 offen offset:0 lds
    v_mfma_f32_32x32x16_bf16 v[76:91], v[156:159], a[76:79], v[76:91]
    ds_read_b64_tr_b16 v[132:133], v33 offset:51200
    ds_read_b64_tr_b16 v[134:135], v33 offset:52224
    v_mfma_f32_32x32x16_bf16 v[92:107], v[160:163], a[72:75], v[92:107]
    ds_read_b64_tr_b16 v[136:137], v34 offset:51200
    ds_read_b64_tr_b16 v[138:139], v34 offset:52224
    buffer_load_dwordx4 v38, s[20:23], s36 offen offset:1024 lds
    v_mfma_f32_32x32x16_bf16 v[108:123], v[160:163], a[76:79], v[108:123]
    s_waitcnt lgkmcnt(4)
    v_mfma_f32_32x32x16_bf16 v[60:75], v[124:127], a[80:83], v[60:75]
    buffer_load_dwordx4 a[168:171], v30, s[28:31], s39 offen offset:1024 sc1
    v_mfma_f32_32x32x16_bf16 v[76:91], v[124:127], a[84:87], v[76:91]
    ds_read_b64_tr_b16 v[140:141], v35 offset:8192
    ds_read_b64_tr_b16 v[142:143], v35 offset:9216
    buffer_load_dwordx4 a[172:175], v31, s[28:31], s39 offen offset:1024 sc1
    s_add_u32 s39, s39, 2048
    s_cmp_eq_u32 s39, s41
    s_cselect_b32 s39, s40, s39
    v_mfma_f32_32x32x16_bf16 v[92:107], v[128:131], a[80:83], v[92:107]
    ds_read_b64_tr_b16 v[144:145], v36 offset:8192
    ds_read_b64_tr_b16 v[146:147], v36 offset:9216
    v_mfma_f32_32x32x16_bf16 v[108:123], v[128:131], a[84:87], v[108:123]
    buffer_load_dwordx4 v39, s[20:23], s36 offen offset:2048 lds
    s_waitcnt vmcnt(11)
    v_cmp_ne_u32 vcc, v59, v20
    s_nop 1
    s_and_b64 s[86:87], vcc, s[54:55]
    s_cbranch_scc0 L_pollok_14
    s_mov_b32 s65, 0
    s_mov_b32 s61, 393216
L_poll_13:
    s_mov_b64 exec, s[86:87]
    buffer_load_dword v59, v56, s[28:31], s61 offen sc1
    s_mov_b64 exec, -1
    s_waitcnt vmcnt(0)
    v_cmp_ne_u32 vcc, v59, v20
    s_add_u32 s65, s65, 1
    s_nop 0
    s_and_b64 s[86:87], vcc, s[54:55]
    s_cbranch_scc0 L_pollok_14
    s_cmp_lt_u32 s65, 20000
    s_cbranch_scc1 L_poll_13
L_pollok_14:
    v_lshlrev_b32 v2, 2, v8
    s_lshl_b32 s61, s46, 7
    s_add_u32 s61, s61, 24576
    s_xor_b32 s62, s61, 128
    v_add_u32 v3, 0x2000, v2
    buffer_load_dword v12, v2, s[28:31], s61 offen sc1
    buffer_load_dword v10, v3, s[28:31], s61 offen sc1
    buffer_load_dword v13, v2, s[28:31], s62 offen sc1
    buffer_load_dword v11, v3, s[28:31], s62 offen sc1
    s_waitcnt lgkmcnt(4)
    v_mfma_f32_32x32x16_bf16 v[60:75], v[132:135], a[88:91], v[60:75]
    v_mfma_f32_32x32x16_bf16 v[76:91], v[132:135], a[92:95], v[76:91]
    ds_read_b64_tr_b16 v[148:149], v35 offset:10240
    ds_read_b64_tr_b16 v[150:151], v35 offset:11264
    buffer_load_dwordx4 v40, s[20:23], s36 offen offset:3072 lds
    s_mov_b32 s37, s38
    s_add_u32 s38, s37, 57344
    s_and_b32 s36, s42, 1
    s_mul_i32 s36, s36, 28672
    s_add_u32 s36, s36, s37
    v_mfma_f32_32x32x16_bf16 v[92:107], v[136:139], a[88:91], v[92:107]
    ds_read_b64_tr_b16 v[152:153], v36 offset:10240
    ds_read_b64_tr_b16 v[154:155], v36 offset:11264
    buffer_load_dwordx4 a[176:179], v30, s[28:31], s39 offen offset:0 sc1
    v_mfma_f32_32x32x16_bf16 v[108:123], v[136:139], a[92:95], v[108:123]
    s_waitcnt lgkmcnt(4)
    v_mfma_f32_32x32x16_bf16 v[60:75], v[140:143], a[96:99], v[60:75]
    buffer_load_dwordx4 a[180:183], v31, s[28:31], s39 offen offset:0 sc1
    v_mfma_f32_32x32x16_bf16 v[76:91], v[140:143], a[100:103], v[76:91]
    ds_read_b64_tr_b16 v[156:157], v35 offset:0
    ds_read_b64_tr_b16 v[158:159], v35 offset:1024
    v_mfma_f32_32x32x16_bf16 v[92:107], v[144:147], a[96:99], v[92:107]
    ds_read_b64_tr_b16 v[160:161], v36 offset:0
    ds_read_b64_tr_b16 v[162:163], v36 offset:1024
    s_add_u32 m0, s44, 49152
    s_nop 0
    buffer_load_dwordx4 v37, s[20:23], s36 offen offset:0 lds
    v_mfma_f32_32x32x16_bf16 v[108:123], v[144:147], a[100:103], v[108:123]
    buffer_load_dwordx4 v38, s[20:23], s36 offen offset:1024 lds
    s_waitcnt lgkmcnt(4)
    v_mfma_f32_32x32x16_bf16 v[60:75], v[148:151], a[104:107], v[60:75]
    v_mfma_f32_32x32x16_bf16 v[76:91], v[148:151], a[108:111], v[76:91]
    ds_read_b64_tr_b16 v[124:125], v35 offset:2048
    ds_read_b64_tr_b16 v[126:127], v35 offset:3072
    buffer_load_dwordx4 a[184:187], v30, s[28:31], s39 offen offset:1024 sc1
    v_mfma_f32_32x32x16_bf16 v[92:107], v[152:155], a[104:107], v[92:107]
    ds_read_b64_tr_b16 v[128:129], v36 offset:2048
    ds_read_b64_tr_b16 v[130:131], v36 offset:3072
    v_mfma_f32_32x32x16_bf16 v[108:123], v[152:155], a[108:111], v[108:123]
    buffer_load_dwordx4 a[188:191], v31, s[28:31], s39 offen offset:1024 sc1
    s_mov_b32 s40, s41
    s_add_u32 s41, s40, 4096
    s_and_b32 s39, s42, 1
    s_lshl_b32 s39, s39, 11
    s_add_u32 s39, s39, s40
    s_waitcnt lgkmcnt(4)
    v_mfma_f32_32x32x16_bf16 v[60:75], v[156:159], a[112:115], v[60:75]
    buffer_load_dwordx4 v39, s[20:23], s36 offen offset:2048 lds
    v_mfma_f32_32x32x16_bf16 v[76:91], v[156:159], a[116:119], v[76:91]
    ds_read_b64_tr_b16 v[132:133], v35 offset:4096
    ds_read_b64_tr_b16 v[134:135], v35 offset:5120
    v_mfma_f32_32x32x16_bf16 v[92:107], v[160:163], a[112:115], v[92:107]
    ds_read_b64_tr_b16 v[136:137], v36 offset:4096
    ds_read_b64_tr_b16 v[138:139], v36 offset:5120
    buffer_load_dwordx4 v40, s[20:23], s36 offen offset:3072 lds
    s_add_u32 s36, s36, 28672
    s_cmp_eq_u32 s36, s38
    s_cselect_b32 s36, s37, s36
    v_mfma_f32_32x32x16_bf16 v[108:123], v[160:163], a[116:119], v[108:123]
    s_waitcnt lgkmcnt(4)
    v_mfma_f32_32x32x16_bf16 v[60:75], v[124:127], a[120:123], v[60:75]
    buffer_load_dwordx4 a[192:195], v30, s[28:31], s39 offen offset:0 sc1
    v_mfma_f32_32x32x16_bf16 v[76:91], v[124:127], a[124:127], v[76:91]
    ds_read_b64_tr_b16 v[140:141], v35 offset:6144
    ds_read_b64_tr_b16 v[142:143], v35 offset:7168
    buffer_load_dwordx4 a[196:199], v31, s[28:31], s39 offen offset:0 sc1
    v_mfma_f32_32x32x16_bf16 v[92:107], v[128:131], a[120:123], v[92:107]
    ds_read_b64_tr_b16 v[144:145], v36 offset:6144
    ds_read_b64_tr_b16 v[146:147], v36 offset:7168
    v_mfma_f32_32x32x16_bf16 v[108:123], v[128:131], a[124:127], v[108:123]
    s_add_u32 m0, s45, 8192
    s_nop 0
    buffer_load_dwordx4 v37, s[20:23], s36 offen offset:0 lds
    s_waitcnt lgkmcnt(4)
    v_mfma_f32_32x32x16_bf16 v[60:75], v[132:135], a[128:131], v[60:75]
    v_mfma_f32_32x32x16_bf16 v[76:91], v[132:135], a[132:135], v[76:91]
    ds_read_b64_tr_b16 v[148:149], v33 offset:0
    ds_read_b64_tr_b16 v[150:151], v33 offset:1024
    buffer_load_dwordx4 v38, s[20:23], s36 offen offset:1024 lds
    v_mfma_f32_32x32x16_bf16 v[92:107], v[136:139], a[128:131], v[92:107]
    ds_read_b64_tr_b16 v[152:153], v34 offset:0
    ds_read_b64_tr_b16 v[154:155], v34 offset:1024
    buffer_load_dwordx4 a[200:203], v30, s[28:31], s39 offen offset:1024 sc1
    v_mfma_f32_32x32x16_bf16 v[108:123], v[136:139], a[132:135], v[108:123]
    s_mov_b32 s65, 917504
    s_cmp_eq_u64 s[92:93], 0
    s_cselect_b64 exec, 1, s[92:93]
    buffer_load_dword v58, v57, s[28:31], s65 offen sc1
    s_mov_b64 exec, -1
    s_waitcnt lgkmcnt(4)
    v_mfma_f32_32x32x16_bf16 v[60:75], v[140:143], a[136:139], v[60:75]
    buffer_load_dwordx4 a[204:207], v31, s[28:31], s39 offen offset:1024 sc1
    s_add_u32 s39, s39, 2048
    s_cmp_eq_u32 s39, s41
    s_cselect_b32 s39, s40, s39
    v_mfma_f32_32x32x16_bf16 v[76:91], v[140:143], a[140:143], v[76:91]
    ds_read_b64_tr_b16 v[156:157], v33 offset:2048
    ds_read_b64_tr_b16 v[158:159], v33 offset:3072
    v_mfma_f32_32x32x16_bf16 v[92:107], v[144:147], a[136:139], v[92:107]
    ds_read_b64_tr_b16 v[160:161], v34 offset:2048
    ds_read_b64_tr_b16 v[162:163], v34 offset:3072
    buffer_load_dwordx4 v39, s[20:23], s36 offen offset:2048 lds
    v_mfma_f32_32x32x16_bf16 v[108:123], v[144:147], a[140:143], v[108:123]
    buffer_load_dwordx4 v40, s[20:23], s36 offen offset:3072 lds
    s_mul_i32 s37, s3, 100352
    s_lshl_b32 s36, s59, 7
    s_add_u32 s37, s37, s36
    s_add_u32 s38, s37, 100352
    s_mul_i32 s36, s42, 25088
    s_add_u32 s36, s36, s37
    s_waitcnt lgkmcnt(4)
    v_mfma_f32_32x32x16_bf16 v[60:75], v[148:151], a[144:147], v[60:75]
    v_mfma_f32_32x32x16_bf16 v[76:91], v[148:151], a[148:151], v[76:91]
    ds_read_b64_tr_b16 v[124:125], v33 offset:16384
    ds_read_b64_tr_b16 v[126:127], v33 offset:17408
    buffer_load_dwordx4 a[208:211], v30, s[28:31], s39 offen offset:0 sc1
    v_mfma_f32_32x32x16_bf16 v[92:107], v[152:155], a[144:147], v[92:107]
    ds_read_b64_tr_b16 v[128:129], v34 offset:16384
    ds_read_b64_tr_b16 v[130:131], v34 offset:17408
    v_mfma_f32_32x32x16_bf16 v[108:123], v[152:155], a[148:151], v[108:123]
    buffer_load_dwordx4 a[212:215], v31, s[28:31], s39 offen offset:0 sc1
    s_waitcnt vmcnt(34) lgkmcnt(4)
    v_mfma_f32_32x32x16_bf16 v[60:75], v[156:159], a[152:155], v[60:75]
    s_add_u32 m0, s45, 0
    s_nop 0
    buffer_load_dwordx4 v37, s[24:27], s36 offen offset:0 lds
    v_mfma_f32_32x32x16_bf16 v[76:91], v[156:159], a[156:159], v[76:91]
    s_waitcnt vmcnt(33)
    ds_read_b64_tr_b16 v[132:133], v33 offset:18432
    ds_read_b64_tr_b16 v[134:135], v33 offset:19456
    v_mfma_f32_32x32x16_bf16 v[92:107], v[160:163], a[152:155], v[92:107]
    ds_read_b64_tr_b16 v[136:137], v34 offset:18432
    ds_read_b64_tr_b16 v[138:139], v34 offset:19456
    buffer_load_dwordx4 v38, s[24:27], s36 offen offset:1024 lds
    v_mfma_f32_32x32x16_bf16 v[108:123], v[160:163], a[156:159], v[108:123]
    s_waitcnt vmcnt(31) lgkmcnt(4)
    v_mfma_f32_32x32x16_bf16 v[60:75], v[124:127], a[160:163], v[60:75]
    buffer_load_dwordx4 a[216:219], v30, s[28:31], s39 offen offset:1024 sc1
    v_mfma_f32_32x32x16_bf16 v[76:91], v[124:127], a[164:167], v[76:91]
    s_waitcnt vmcnt(30)
    ds_read_b64_tr_b16 v[140:141], v33 offset:32768
    ds_read_b64_tr_b16 v[142:143], v33 offset:33792
    buffer_load_dwordx4 a[220:223], v31, s[28:31], s39 offen offset:1024 sc1
    s_lshl_b32 s40, s3, 13
    s_add_u32 s40, s40, 14680064
    s_add_u32 s41, s40, 8192
    s_lshl_b32 s39, s42, 11
    s_add_u32 s39, s39, s40
    v_mfma_f32_32x32x16_bf16 v[92:107], v[128:131], a[160:163], v[92:107]
    ds_read_b64_tr_b16 v[144:145], v34 offset:32768
    ds_read_b64_tr_b16 v[146:147], v34 offset:33792
    v_mfma_f32_32x32x16_bf16 v[108:123], v[128:131], a[164:167], v[108:123]
    buffer_load_dwordx4 v39, s[24:27], s36 offen offset:2048 lds
    s_waitcnt vmcnt(10)
    v_cmp_ne_u32 vcc, v58, v20
    s_nop 1
    s_and_b64 s[86:87], vcc, s[92:93]
    s_cbranch_scc0 L_pollok_16
    s_mov_b32 s65, 0
    s_mov_b32 s61, 917504
L_poll_15:
    s_mov_b64 exec, s[86:87]
    buffer_load_dword v58, v57, s[28:31], s61 offen sc1
    s_mov_b64 exec, -1
    s_waitcnt vmcnt(0)
    v_cmp_ne_u32 vcc, v58, v20
    s_add_u32 s65, s65, 1
    s_nop 0
    s_and_b64 s[86:87], vcc, s[92:93]
    s_cbranch_scc0 L_pollok_16
    s_cmp_lt_u32 s65, 20000
    s_cbranch_scc1 L_poll_15
L_pollok_16:
    s_waitcnt lgkmcnt(4)
    v_mfma_f32_32x32x16_bf16 v[60:75], v[132:135], a[168:171], v[60:75]
    v_mfma_f32_32x32x16_bf16 v[76:91], v[132:135], a[172:175], v[76:91]
    ds_read_b64_tr_b16 v[148:149], v33 offset:34816
    ds_read_b64_tr_b16 v[150:151], v33 offset:35840
    buffer_load_dwordx4 v41, s[24:27], s36 offen offset:3072 lds
    s_add_u32 s36, s36, 25088
    s_cmp_eq_u32 s36, s38
    s_cselect_b32 s36, s37, s36
    v_mfma_f32_32x32x16_bf16 v[92:107], v[136:139], a[168:171], v[92:107]
    ds_read_b64_tr_b16 v[152:153], v34 offset:34816
    ds_read_b64_tr_b16 v[154:155], v34 offset:35840
    buffer_load_dwordx4 a[0:3], v53, s[28:31], s39 offen offset:0 sc1
    v_mfma_f32_32x32x16_bf16 v[108:123], v[136:139], a[172:175], v[108:123]
    s_waitcnt lgkmcnt(4)
    v_mfma_f32_32x32x16_bf16 v[60:75], v[140:143], a[176:179], v[60:75]
    buffer_load_dwordx4 a[4:7], v54, s[28:31], s39 offen offset:0 sc1
    v_mfma_f32_32x32x16_bf16 v[76:91], v[140:143], a[180:183], v[76:91]
    ds_read_b64_tr_b16 v[156:157], v33 offset:49152
    ds_read_b64_tr_b16 v[158:159], v33 offset:50176
    v_mfma_f32_32x32x16_bf16 v[92:107], v[144:147], a[176:179], v[92:107]
    ds_read_b64_tr_b16 v[160:161], v34 offset:49152
    ds_read_b64_tr_b16 v[162:163], v34 offset:50176
    s_add_u32 m0, s45, 4096
    s_nop 0
    buffer_load_dwordx4 v37, s[24:27], s36 offen offset:0 lds
    v_mfma_f32_32x32x16_bf16 v[108:123], v[144:147], a[180:183], v[108:123]
    buffer_load_dwordx4 v38, s[24:27], s36 offen offset:1024 lds
    s_waitcnt lgkmcnt(4)
    v_mfma_f32_32x32x16_bf16 v[60:75], v[148:151], a[184:187], v[60:75]
    v_mfma_f32_32x32x16_bf16 v[76:91], v[148:151], a[188:191], v[76:91]
    ds_read_b64_tr_b16 v[124:125], v33 offset:51200
    ds_read_b64_tr_b16 v[126:127], v33 offset:52224
    buffer_load_dwordx4 a[8:11], v53, s[28:31], s39 offen offset:1024 sc1
    v_mfma_f32_32x32x16_bf16 v[92:107], v[152:155], a[184:187], v[92:107]
    ds_read_b64_tr_b16 v[128:129], v34 offset:51200
    ds_read_b64_tr_b16 v[130:131], v34 offset:52224
    v_mfma_f32_32x32x16_bf16 v[108:123], v[152:155], a[188:191], v[108:123]
    buffer_load_dwordx4 a[12:15], v54, s[28:31], s39 offen offset:1024 sc1
    s_add_u32 s39, s39, 2048
    s_cmp_eq_u32 s39, s41
    s_cselect_b32 s39, s40, s39
    s_waitcnt lgkmcnt(4)
    v_mfma_f32_32x32x16_bf16 v[60:75], v[156:159], a[192:195], v[60:75]
    buffer_load_dwordx4 v39, s[24:27], s36 offen offset:2048 lds
    v_mfma_f32_32x32x16_bf16 v[76:91], v[156:159], a[196:199], v[76:91]
    ds_read_b64_tr_b16 v[132:133], v35 offset:8192
    ds_read_b64_tr_b16 v[134:135], v35 offset:9216
    buffer_load_dwordx4 v41, s[24:27], s36 offen offset:3072 lds
    s_add_u32 s36, s36, 25088
    s_cmp_eq_u32 s36, s38
    s_cselect_b32 s36, s37, s36
    v_mfma_f32_32x32x16_bf16 v[92:107], v[160:163], a[192:195], v[92:107]
    ds_read_b64_tr_b16 v[136:137], v36 offset:8192
    ds_read_b64_tr_b16 v[138:139], v36 offset:9216
    v_mfma_f32_32x32x16_bf16 v[108:123], v[160:163], a[196:199], v[108:123]
    s_waitcnt vmcnt(18) lgkmcnt(4)
    v_mfma_f32_32x32x16_bf16 v[60:75], v[124:127], a[200:203], v[60:75]
    buffer_load_dwordx4 a[16:19], v53, s[28:31], s39 offen offset:0 sc1
    v_mfma_f32_32x32x16_bf16 v[76:91], v[124:127], a[204:207], v[76:91]
    s_waitcnt vmcnt(17)
    ds_read_b64_tr_b16 v[140:141], v35 offset:10240
    ds_read_b64_tr_b16 v[142:143], v35 offset:11264
    buffer_load_dwordx4 a[20:23], v54, s[28:31], s39 offen offset:0 sc1
    v_mfma_f32_32x32x16_bf16 v[92:107], v[128:131], a[200:203], v[92:107]
    ds_read_b64_tr_b16 v[144:145], v36 offset:10240
    ds_read_b64_tr_b16 v[146:147], v36 offset:11264
    s_add_u32 m0, s44, 0
    s_nop 0
    buffer_load_dwordx4 v37, s[24:27], s36 offen offset:0 lds
    v_mfma_f32_32x32x16_bf16 v[108:123], v[128:131], a[204:207], v[108:123]
    buffer_load_dwordx4 v38, s[24:27], s36 offen offset:1024 lds
    s_waitcnt vmcnt(18) lgkmcnt(4)
    v_mfma_f32_32x32x16_bf16 v[60:75], v[132:135], a[208:211], v[60:75]
    buffer_load_dwordx4 a[24:27], v53, s[28:31], s39 offen offset:1024 sc1
    v_mfma_f32_32x32x16_bf16 v[76:91], v[132:135], a[212:215], v[76:91]
    s_waitcnt vmcnt(17)
    ds_read_b64_tr_b16 v[148:149], v35 offset:0
    ds_read_b64_tr_b16 v[150:151], v35 offset:1024
    buffer_load_dwordx4 a[28:31], v54, s[28:31], s39 offen offset:1024 sc1
    s_add_u32 s39, s39, 2048
    s_cmp_eq_u32 s39, s41
    s_cselect_b32 s39, s40, s39
    v_mfma_f32_32x32x16_bf16 v[92:107], v[136:139], a[208:211], v[92:107]
    ds_read_b64_tr_b16 v[152:153], v36 offset:0
    ds_read_b64_tr_b16 v[154:155], v36 offset:1024
    buffer_load_dwordx4 v39, s[24:27], s36 offen offset:2048 lds
    v_mfma_f32_32x32x16_bf16 v[108:123], v[136:139], a[212:215], v[108:123]
    buffer_load_dwordx4 v41, s[24:27], s36 offen offset:3072 lds
    s_add_u32 s36, s36, 25088
    s_cmp_eq_u32 s36, s38
    s_cselect_b32 s36, s37, s36
    s_waitcnt vmcnt(18) lgkmcnt(4)
    v_mfma_f32_32x32x16_bf16 v[60:75], v[140:143], a[216:219], v[60:75]
    buffer_load_dwordx4 a[32:35], v53, s[28:31], s39 offen offset:0 sc1
    v_mfma_f32_32x32x16_bf16 v[76:91], v[140:143], a[220:223], v[76:91]
    s_waitcnt vmcnt(17)
    ds_read_b64_tr_b16 v[156:157], v35 offset:2048
    ds_read_b64_tr_b16 v[158:159], v35 offset:3072
    buffer_load_dwordx4 a[36:39], v54, s[28:31], s39 offen offset:0 sc1
    v_mfma_f32_32x32x16_bf16 v[92:107], v[144:147], a[216:219], v[92:107]
    ds_read_b64_tr_b16 v[160:161], v36 offset:2048
    ds_read_b64_tr_b16 v[162:163], v36 offset:3072
    buffer_load_dwordx4 a[40:43], v53, s[28:31], s39 offen offset:1024 sc1
    v_mfma_f32_32x32x16_bf16 v[108:123], v[144:147], a[220:223], v[108:123]
    buffer_load_dwordx4 a[44:47], v54, s[28:31], s39 offen offset:1024 sc1
    s_add_u32 s39, s39, 2048
    s_cmp_eq_u32 s39, s41
    s_cselect_b32 s39, s40, s39
    s_waitcnt vmcnt(18) lgkmcnt(4)
    v_mfma_f32_32x32x16_bf16 v[164:179], v[148:151], a[0:3], 0
    buffer_load_dwordx4 a[48:51], v53, s[28:31], s39 offen offset:0 sc1
    v_mfma_f32_32x32x16_bf16 v[180:195], v[148:151], a[4:7], 0
    v_mul_f32 v60, v60, v10
    v_mul_f32 v61, v61, v10
    v_mul_f32 v62, v62, v10
    v_mul_f32 v63, v63, v10
    v_mul_f32 v64, v64, v10
    s_waitcnt vmcnt(17)
    ds_read_b64_tr_b16 v[124:125], v35 offset:4096
    ds_read_b64_tr_b16 v[126:127], v35 offset:5120
    buffer_load_dwordx4 a[52:55], v54, s[28:31], s39 offen offset:0 sc1
    v_mfma_f32_32x32x16_bf16 v[196:211], v[152:155], a[0:3], 0
    v_mul_f32 v65, v65, v10
    v_mul_f32 v66, v66, v10
    v_mul_f32 v67, v67, v10
    v_mul_f32 v68, v68, v10
    v_mul_f32 v69, v69, v10
    ds_read_b64_tr_b16 v[128:129], v36 offset:4096
    ds_read_b64_tr_b16 v[130:131], v36 offset:5120
    buffer_load_dwordx4 a[56:59], v53, s[28:31], s39 offen offset:1024 sc1
    v_mfma_f32_32x32x16_bf16 v[220:235], v[152:155], a[4:7], 0
    v_mul_f32 v70, v70, v10
    v_mul_f32 v71, v71, v10
    v_mul_f32 v72, v72, v10
    v_mul_f32 v73, v73, v10
    v_mul_f32 v74, v74, v10
    buffer_load_dwordx4 a[60:63], v54, s[28:31], s39 offen offset:1024 sc1
    s_waitcnt vmcnt(18) lgkmcnt(4)
    v_mfma_f32_32x32x16_bf16 v[164:179], v[156:159], a[8:11], v[164:179]
    v_mul_f32 v75, v75, v10
    v_mul_f32 v76, v76, v11
    v_mul_f32 v77, v77, v11
    v_mul_f32 v78, v78, v11
    v_mul_f32 v79, v79, v11
    s_add_u32 m0, s44, 16384
    s_nop 0
    buffer_load_dwordx4 v37, s[24:27], s36 offen offset:0 lds
    v_mfma_f32_32x32x16_bf16 v[180:195], v[156:159], a[12:15], v[180:195]
    v_mul_f32 v80, v80, v11
    v_mul_f32 v81, v81, v11
    v_mul_f32 v82, v82, v11
    v_mul_f32 v83, v83, v11
    v_mul_f32 v84, v84, v11
    s_waitcnt vmcnt(17)
    ds_read_b64_tr_b16 v[132:133], v35 offset:6144
    ds_read_b64_tr_b16 v[134:135], v35 offset:7168
    buffer_load_dwordx4 v38, s[24:27], s36 offen offset:1024 lds
    v_mfma_f32_32x32x16_bf16 v[196:211], v[160:163], a[8:11], v[196:211]
    v_mul_f32 v85, v85, v11
    v_mul_f32 v86, v86, v11
    v_mul_f32 v87, v87, v11
    v_mul_f32 v88, v88, v11
    v_mul_f32 v89, v89, v11
    ds_read_b64_tr_b16 v[136:137], v36 offset:6144
    ds_read_b64_tr_b16 v[138:139], v36 offset:7168
    buffer_load_dwordx4 v39, s[24:27], s36 offen offset:2048 lds
    v_mfma_f32_32x32x16_bf16 v[220:235], v[160:163], a[12:15], v[220:235]
    v_mul_f32 v90, v90, v11
    v_mul_f32 v91, v91, v11
    v_mul_f32 v92, v92, v10
    v_mul_f32 v93, v93, v10
    v_mul_f32 v94, v94, v10
    buffer_load_dwordx4 v41, s[24:27], s36 offen offset:3072 lds
    s_waitcnt vmcnt(18) lgkmcnt(4)
    v_mfma_f32_32x32x16_bf16 v[164:179], v[124:127], a[16:19], v[164:179]
    v_mul_f32 v95, v95, v10
    v_mul_f32 v96, v96, v10
    v_mul_f32 v97, v97, v10
    v_mul_f32 v98, v98, v10
    v_mul_f32 v99, v99, v10
    v_mfma_f32_32x32x16_bf16 v[180:195], v[124:127], a[20:23], v[180:195]
    v_mul_f32 v100, v100, v10
    v_mul_f32 v101, v101, v10
    v_mul_f32 v102, v102, v10
    v_mul_f32 v103, v103, v10
    v_mul_f32 v104, v104, v10
    s_waitcnt vmcnt(16)
    ds_read_b64_tr_b16 v[140:141], v33 offset:0
    ds_read_b64_tr_b16 v[142:143], v33 offset:1024
    v_mfma_f32_32x32x16_bf16 v[196:211], v[128:131], a[16:19], v[196:211]
    v_mul_f32 v105, v105, v10
    v_mul_f32 v106, v106, v10
    v_mul_f32 v107, v107, v10
    v_mul_f32 v108, v108, v11
    v_mul_f32 v109, v109, v11
    ds_read_b64_tr_b16 v[144:145], v34 offset:0
    ds_read_b64_tr_b16 v[146:147], v34 offset:1024
    v_mfma_f32_32x32x16_bf16 v[220:235], v[128:131], a[20:23], v[220:235]
    v_mul_f32 v110, v110, v11
    v_mul_f32 v111, v111, v11
    v_mul_f32 v112, v112, v11
    v_mul_f32 v113, v113, v11
    v_mul_f32 v114, v114, v11
    s_waitcnt vmcnt(14) lgkmcnt(4)
    v_mfma_f32_32x32x16_bf16 v[164:179], v[132:135], a[24:27], v[164:179]
    v_mul_f32 v115, v115, v11
    v_mul_f32 v116, v116, v11
    v_mul_f32 v117, v117, v11
    v_mul_f32 v118, v118, v11
    v_mul_f32 v119, v119, v11
    v_mfma_f32_32x32x16_bf16 v[180:195], v[132:135], a[28:31], v[180:195]
    v_mul_f32 v120, v120, v11
    v_mul_f32 v121, v121, v11
    v_mul_f32 v122, v122, v11
    v_mul_f32 v123, v123, v11
    s_waitcnt vmcnt(12)
    s_waitcnt vmcnt(2)
    s_waitcnt vmcnt(0)
    ds_read_b64_tr_b16 v[148:149], v33 offset:2048
    ds_read_b64_tr_b16 v[150:151], v33 offset:3072
    ds_read_b64_tr_b16 v[152:153], v34 offset:2048
    ds_read_b64_tr_b16 v[154:155], v34 offset:3072
    v_mfma_f32_32x32x16_bf16 v[196:211], v[136:139], a[24:27], v[196:211]
    ds_read_b64_tr_b16 v[156:157], v33 offset:16384
    ds_read_b64_tr_b16 v[158:159], v33 offset:17408
    ds_read_b64_tr_b16 v[160:161], v34 offset:16384
    ds_read_b64_tr_b16 v[162:163], v34 offset:17408
    v_mfma_f32_32x32x16_bf16 v[220:235], v[136:139], a[28:31], v[220:235]
    ds_read_b64_tr_b16 v[124:125], v33 offset:18432
    ds_read_b64_tr_b16 v[126:127], v33 offset:19456
    ds_read_b64_tr_b16 v[128:129], v34 offset:18432
    ds_read_b64_tr_b16 v[130:131], v34 offset:19456
    s_waitcnt lgkmcnt(12)
    v_mfma_f32_32x32x16_bf16 v[180:195], v[140:143], a[36:39], v[180:195]
    s_xor_b32 s61, s3, 1
    s_mul_i32 s61, s61, 12288
    s_add_u32 s61, s61, 65536
    v_add_u32 v14, s61, v32
    s_xor_b32 s61, s3, 2
    s_mul_i32 s61, s61, 12288
    s_add_u32 s61, s61, 69632
    s_waitcnt lgkmcnt(8)
    v_mfma_f32_32x32x16_bf16 v[180:195], v[148:151], a[44:47], v[180:195]
    v_add_u32 v15, s61, v32
    s_xor_b32 s61, s3, 3
    s_mul_i32 s61, s61, 12288
    s_add_u32 s61, s61, 73728
    v_add_u32 v16, s61, v32
    s_mul_i32 s61, s3, 12288
    s_add_u32 s61, s61, 65536
    s_waitcnt lgkmcnt(4)
    v_mfma_f32_32x32x16_bf16 v[180:195], v[156:159], a[52:55], v[180:195]
    v_add_u32 v17, s61, v32
    s_waitcnt lgkmcnt(0)
    v_mfma_f32_32x32x16_bf16 v[180:195], v[124:127], a[60:63], v[180:195]
    v_mfma_f32_32x32x16_bf16 v[196:211], v[144:147], a[32:35], v[196:211]
    v_mfma_f32_32x32x16_bf16 v[196:211], v[152:155], a[40:43], v[196:211]
    s_nop 9
    v_fmac_f32 v76, v180, v13
    v_fmac_f32 v77, v181, v13
    v_fmac_f32 v78, v182, v13
    v_fmac_f32 v79, v183, v13
    ds_write_b128 v14, v[76:79] offset:0
    v_fmac_f32 v80, v184, v13
    v_fmac_f32 v81, v185, v13
    v_mfma_f32_32x32x16_bf16 v[196:211], v[160:163], a[48:51], v[196:211]
    v_fmac_f32 v82, v186, v13
    v_fmac_f32 v83, v187, v13
    ds_write_b128 v14, v[80:83] offset:1024
    v_fmac_f32 v84, v188, v13
    v_fmac_f32 v85, v189, v13
    v_fmac_f32 v86, v190, v13
    v_fmac_f32 v87, v191, v13
    v_mfma_f32_32x32x16_bf16 v[196:211], v[128:131], a[56:59], v[196:211]
    ds_write_b128 v14, v[84:87] offset:2048
    v_fmac_f32 v88, v192, v13
    v_fmac_f32 v89, v193, v13
    v_fmac_f32 v90, v194, v13
    v_fmac_f32 v91, v195, v13
    ds_write_b128 v14, v[88:91] offset:3072
    v_mfma_f32_32x32x16_bf16 v[220:235], v[144:147], a[36:39], v[220:235]
    v_mfma_f32_32x32x16_bf16 v[220:235], v[152:155], a[44:47], v[220:235]
    s_nop 3
    v_fmac_f32 v92, v196, v12
    v_fmac_f32 v93, v197, v12
    v_fmac_f32 v94, v198, v12
    v_fmac_f32 v95, v199, v12
    ds_write_b128 v15, v[92:95] offset:0
    v_fmac_f32 v96, v200, v12
    v_fmac_f32 v97, v201, v12
    v_mfma_f32_32x32x16_bf16 v[220:235], v[160:163], a[52:55], v[220:235]
    v_fmac_f32 v98, v202, v12
    v_fmac_f32 v99, v203, v12
    ds_write_b128 v15, v[96:99] offset:1024
    v_fmac_f32 v100, v204, v12
    v_fmac_f32 v101, v205, v12
    v_fmac_f32 v102, v206, v12
    v_fmac_f32 v103, v207, v12
    v_mfma_f32_32x32x16_bf16 v[220:235], v[128:131], a[60:63], v[220:235]
    ds_write_b128 v15, v[100:103] offset:2048
    v_fmac_f32 v104, v208, v12
    v_fmac_f32 v105, v209, v12
    v_fmac_f32 v106, v210, v12
    v_fmac_f32 v107, v211, v12
    ds_write_b128 v15, v[104:107] offset:3072
    v_mfma_f32_32x32x16_bf16 v[164:179], v[140:143], a[32:35], v[164:179]
    v_mfma_f32_32x32x16_bf16 v[164:179], v[148:151], a[40:43], v[164:179]
    s_nop 3
    v_fmac_f32 v108, v220, v13
    v_fmac_f32 v109, v221, v13
    v_fmac_f32 v110, v222, v13
    v_fmac_f32 v111, v223, v13
    ds_write_b128 v16, v[108:111] offset:0
    v_fmac_f32 v112, v224, v13
    v_fmac_f32 v113, v225, v13
    v_mfma_f32_32x32x16_bf16 v[164:179], v[156:159], a[48:51], v[164:179]
    v_fmac_f32 v114, v226, v13
    v_fmac_f32 v115, v227, v13
    ds_write_b128 v16, v[112:115] offset:1024
    v_fmac_f32 v116, v228, v13
    v_fmac_f32 v117, v229, v13
    v_fmac_f32 v118, v230, v13
    v_fmac_f32 v119, v231, v13
    v_mfma_f32_32x32x16_bf16 v[164:179], v[124:127], a[56:59], v[164:179]
    ds_write_b128 v16, v[116:119] offset:2048
    v_fmac_f32 v120, v232, v13
    v_fmac_f32 v121, v233, v13
    v_fmac_f32 v122, v234, v13
    v_fmac_f32 v123, v235, v13
    ds_write_b128 v16, v[120:123] offset:3072
    v_mul_u32_u24 v2, 896, v8
    v_lshl_add_u32 v2, v7, 4, v2
    s_mul_i32 s61, s46, 28672
    s_lshl_b32 s62, s59, 7
    s_add_u32 s61, s61, s62
    s_lshr_b32 s62, s3, 1
    s_lshl_b32 s62, s62, 6
    s_add_u32 s61, s61, s62
    s_waitcnt lgkmcnt(0)
    s_barrier
    ds_read_b128 v[180:183], v17 offset:0
    ds_read_b128 v[196:199], v17 offset:4096
    ds_read_b128 v[220:223], v17 offset:8192
    ds_read_b128 v[184:187], v17 offset:1024
    ds_read_b128 v[200:203], v17 offset:5120
    ds_read_b128 v[224:227], v17 offset:9216
    ds_read_b128 v[188:191], v17 offset:2048
    ds_read_b128 v[204:207], v17 offset:6144
    ds_read_b128 v[228:231], v17 offset:10240
    ds_read_b128 v[192:195], v17 offset:3072
    ds_read_b128 v[208:211], v17 offset:7168
    ds_read_b128 v[232:235], v17 offset:11264
    v_fmac_f32 v60, v164, v12
    v_fmac_f32 v61, v165, v12
    v_fmac_f32 v62, v166, v12
    v_fmac_f32 v63, v167, v12
    v_fmac_f32 v64, v168, v12
    v_fmac_f32 v65, v169, v12
    v_fmac_f32 v66, v170, v12
    v_fmac_f32 v67, v171, v12
    v_fmac_f32 v68, v172, v12
    v_fmac_f32 v69, v173, v12
    v_fmac_f32 v70, v174, v12
    v_fmac_f32 v71, v175, v12
    v_fmac_f32 v72, v176, v12
    v_fmac_f32 v73, v177, v12
    v_fmac_f32 v74, v178, v12
    v_fmac_f32 v75, v179, v12
    s_waitcnt lgkmcnt(9)
    v_add_f32 v60, v60, v180
    v_add_f32 v196, v196, v220
    v_add_f32 v61, v61, v181
    v_add_f32 v197, v197, v221
    v_add_f32 v62, v62, v182
    v_add_f32 v198, v198, v222
    v_add_f32 v63, v63, v183
    v_add_f32 v199, v199, v223
    v_add_f32 v60, v60, v196
    v_add_f32 v61, v61, v197
    v_add_f32 v62, v62, v198
    v_add_f32 v63, v63, v199
    v_cvt_pk_bf16_f32 v124, v60, v61
    v_cvt_pk_bf16_f32 v125, v62, v63
    s_waitcnt lgkmcnt(6)
    v_add_f32 v64, v64, v184
    v_add_f32 v200, v200, v224
    v_add_f32 v65, v65, v185
    v_add_f32 v201, v201, v225
    v_add_f32 v66, v66, v186
    v_add_f32 v202, v202, v226
    v_add_f32 v67, v67, v187
    v_add_f32 v203, v203, v227
    v_add_f32 v64, v64, v200
    v_add_f32 v65, v65, v201
    v_add_f32 v66, v66, v202
    v_add_f32 v67, v67, v203
    v_cvt_pk_bf16_f32 v126, v64, v65
    v_cvt_pk_bf16_f32 v127, v66, v67
    s_nop 0
    v_permlane32_swap_b32 v124, v126
    v_permlane32_swap_b32 v125, v127
    buffer_store_dwordx4 v[124:127], v2, s[32:35], s61 offen offset:0
    s_waitcnt lgkmcnt(3)
    v_add_f32 v68, v68, v188
    v_add_f32 v204, v204, v228
    v_add_f32 v69, v69, v189
    v_add_f32 v205, v205, v229
    v_add_f32 v70, v70, v190
    v_add_f32 v206, v206, v230
    v_add_f32 v71, v71, v191
    v_add_f32 v207, v207, v231
    v_add_f32 v68, v68, v204
    v_add_f32 v69, v69, v205
    v_add_f32 v70, v70, v206
    v_add_f32 v71, v71, v207
    v_cvt_pk_bf16_f32 v128, v68, v69
    v_cvt_pk_bf16_f32 v129, v70, v71
    s_waitcnt lgkmcnt(0)
    v_add_f32 v72, v72, v192
    v_add_f32 v208, v208, v232
    v_add_f32 v73, v73, v193
    v_add_f32 v209, v209, v233
    v_add_f32 v74, v74, v194
    v_add_f32 v210, v210, v234
    v_add_f32 v75, v75, v195
    v_add_f32 v211, v211, v235
    v_add_f32 v72, v72, v208
    v_add_f32 v73, v73, v209
    v_add_f32 v74, v74, v210
    v_add_f32 v75, v75, v211
    v_cvt_pk_bf16_f32 v130, v72, v73
    v_cvt_pk_bf16_f32 v131, v74, v75
    s_nop 0
    v_permlane32_swap_b32 v128, v130
    v_permlane32_swap_b32 v129, v131
    buffer_store_dwordx4 v[128:131], v2, s[32:35], s61 offen offset:32
L_fin:
L_end:
    s_endpgm
L_idle:
    s_waitcnt vmcnt(0)
    s_mov_b32 s61, 393216
    s_mov_b64 exec, 16
    buffer_store_dword v20, v29, s[28:31], s61 offen sc1
    s_mov_b64 exec, -1
    s_xor_b32 s61, s2, 224
    s_or_b32 s61, s61, s3
    s_cmp_lg_u32 s61, 0
    s_cbranch_scc1 L_fin
    s_mov_b32 s65, 0
    v_lshlrev_b32 v3, 6, v6
L_epoch:
    s_mov_b32 s61, 917504
    buffer_load_dword v60, v3, s[28:31], s61 offen sc1
    s_mov_b32 s61, 921600
    buffer_load_dword v61, v3, s[28:31], s61 offen sc1
    s_mov_b32 s61, 925696
    buffer_load_dword v62, v3, s[28:31], s61 offen sc1
    s_mov_b32 s61, 929792
    buffer_load_dword v63, v3, s[28:31], s61 offen sc1
    s_mov_b32 s61, 933888
    buffer_load_dword v64, v3, s[28:31], s61 offen sc1
    s_mov_b32 s61, 937984
    buffer_load_dword v65, v3, s[28:31], s61 offen sc1
    s_mov_b32 s61, 942080
    buffer_load_dword v66, v3, s[28:31], s61 offen sc1
    s_mov_b32 s61, 946176
    buffer_load_dword v67, v3, s[28:31], s61 offen sc1
    s_mov_b32 s61, 950272
    buffer_load_dword v68, v3, s[28:31], s61 offen sc1
    s_mov_b32 s61, 954368
    buffer_load_dword v69, v3, s[28:31], s61 offen sc1
    s_mov_b32 s61, 958464
    buffer_load_dword v70, v3, s[28:31], s61 offen sc1
    s_mov_b32 s61, 962560
    buffer_load_dword v71, v3, s[28:31], s61 offen sc1
    s_mov_b32 s61, 966656
    buffer_load_dword v72, v3, s[28:31], s61 offen sc1
    s_mov_b32 s61, 970752
    buffer_load_dword v73, v3, s[28:31], s61 offen sc1
    s_mov_b32 s61, 974848
    buffer_load_dword v74, v3, s[28:31], s61 offen sc1
    s_mov_b32 s61, 978944
    buffer_load_dword v75, v3, s[28:31], s61 offen sc1
    s_waitcnt vmcnt(0)
    v_xor_b32 v60, v60, v20
    v_xor_b32 v61, v61, v20
    v_xor_b32 v62, v62, v20
    v_xor_b32 v63, v63, v20
    v_xor_b32 v64, v64, v20
    v_xor_b32 v65, v65, v20
    v_xor_b32 v66, v66, v20
    v_xor_b32 v67, v67, v20
    v_xor_b32 v68, v68, v20
    v_xor_b32 v69, v69, v20
    v_xor_b32 v70, v70, v20
    v_xor_b32 v71, v71, v20
    v_xor_b32 v72, v72, v20
    v_xor_b32 v73, v73, v20
    v_xor_b32 v74, v74, v20
    v_xor_b32 v75, v75, v20
    v_or3_b32 v60, v60, v61, v62
    v_or3_b32 v60, v60, v63, v64
    v_or3_b32 v60, v60, v65, v66
    v_or3_b32 v60, v60, v67, v68
    v_or3_b32 v60, v60, v69, v70
    v_or3_b32 v60, v60, v71, v72
    v_or3_b32 v60, v60, v73, v74
    v_or3_b32 v60, v60, v75, v75
    v_cmp_ne_u32 vcc, 0, v60
    s_add_u32 s65, s65, 1
    s_nop 0
    s_and_b64 s[86:87], vcc, vcc
    s_cbranch_scc0 L_epoch_ok
    s_sleep 16
    s_cmp_lt_u32 s65, 20000
    s_cbranch_scc1 L_epoch
L_epoch_ok:
    s_mov_b32 s61, 0
    v_mov_b32 v2, 0
    s_mov_b64 exec, 1
    buffer_store_dword v20, v2, s[28:31], s61 offen sc1
    s_mov_b64 exec, -1
    s_branch L_fin
.fill 12288, 4, 0xBF810000
.section .rodata,"a"
.p2align 6
.amdhsa_kernel gated_mix__sliding_block__dense_activation_relu__prompt_kernel
  .amdhsa_next_free_vgpr 512
  .amdhsa_next_free_sgpr 102
  .amdhsa_accum_offset 256
  .amdhsa_group_segment_fixed_size 0
  .amdhsa_kernarg_size 80
  .amdhsa_user_sgpr_count 2
  .amdhsa_user_sgpr_kernarg_segment_ptr 1
  .amdhsa_system_sgpr_workgroup_id_x 1
.end_amdhsa_kernel
```
